```python
import torch

def _softmax(x, axis=-1):
    return torch.softmax(x, dim=axis)
def _gelu(x):
    return torch.nn.functional.gelu(x, approximate="tanh")
def _silu(x):
    return torch.nn.functional.silu(x)
def _sigmoid(x):
    return torch.sigmoid(x)
def _layernorm(x, axis=-1, eps=1e-5):
    m = x.mean(dim=axis, keepdim=True)
    v = x.var(dim=axis, keepdim=True, unbiased=False)
    return (x - m) / torch.sqrt(v + eps)
def _scatter_add(tgt, idx, src, axis=0):
    return tgt.clone().index_add_(axis, idx, src)
def _segment_sum(src, seg, n):
    out = torch.zeros((n,) + src.shape[1:], dtype=src.dtype)
    return out.index_add_(0, seg, src)
def _pad(x, pw):
    flat = tuple(v for pair in reversed(pw) for v in pair)
    return torch.nn.functional.pad(x, flat)

kernel_name = 'gated_mix__softmax_full_mha__dense_activation_mish__prompt'

def setup_inputs():

    _w = (lambda a: (lambda t: t.to(torch.bfloat16) if t.is_floating_point() else t)(torch.as_tensor(a)))
    def _A_setup():
        B, S, D = 1, 2048, 512
        return {
            "x": _w((lambda *s: torch.randn(*s, dtype=torch.bfloat16) * 0.05)(B, S, D)),
            "wqkv": _w((lambda *s: torch.randn(*s, dtype=torch.bfloat16) * 0.8)(D, 3 * D)),
            "wo": _w((lambda *s: torch.randn(*s, dtype=torch.bfloat16) * 0.05)(D, D)),
        }
    _A_in = _A_setup()

    def _B_setup():
        B, S, D, F = 1, 2048, 512, 1792
        return {
            "x": _w((lambda *s: torch.randn(*s, dtype=torch.bfloat16) * 0.05)(B, S, D)),
            "w1": _w((lambda *s: torch.randn(*s, dtype=torch.bfloat16) * 12.8)(D, F) * (D ** -0.5)),
            "b1": _w((lambda *s: torch.randn(*s, dtype=torch.bfloat16) * 0.2)(F)),
            "w2": _w((lambda *s: torch.randn(*s, dtype=torch.bfloat16) * 0.1)(F, D) * (F ** -0.5)),
        }
    _B_in = _B_setup()

    return {
        "A_x": _A_in["x"],
        "A_wqkv": _A_in["wqkv"],
        "A_wo": _A_in["wo"],
        "B_x": _B_in["x"],
        "B_w1": _B_in["w1"],
        "B_b1": _B_in["b1"],
        "B_w2": _B_in["w2"],
        "gate_w": _w((lambda *s: torch.randn(*s, dtype=torch.bfloat16) * 0.05)(512) * 16.0),
    }

def reference(A_x, A_wqkv, A_wo, B_x, B_w1, B_b1, B_w2, gate_w):
    def _A_ref(x, wqkv, wo):
        B, S, D = x.shape
        H = 32; Dh = D // H
        qkv = (lambda x, *d: x.permute(*d))((x @ wqkv).reshape(B, S, 3, H, Dh), 2, 0, 3, 1, 4)
        q, k, v = qkv[0], qkv[1], qkv[2]
        scale = Dh ** -0.5
        scores = torch.einsum("bhqd,bhkd->bhqk", q, k) * scale
        p = _softmax(scores, axis=-1)
        o = torch.einsum("bhqk,bhkd->bhqd", p, v)
        return (lambda x, *d: x.permute(*d))(o, 0, 2, 1, 3).reshape(B, S, D) @ wo

    def _B_ref(x, w1, b1, w2):
        h = torch.einsum("bsd,df->bsf", x, w1) + b1
        sp = torch.log1p(torch.exp(-torch.abs(h))) + torch.where(h > 0, h, torch.zeros_like(h))
        act = h * torch.tanh(sp)
        return torch.einsum("bsf,fd->bsd", act, w2)

    x = A_x
    g = _sigmoid((x * gate_w).sum(-1, keepdims=True))
    a = _A_ref(x, A_wqkv, A_wo)
    b = _B_ref(x, B_w1, B_b1, B_w2)
    return g * a + (1 - g) * b
```

```asm
; @launch grid=(256,1,1) block=(768,1,1) lds=163840
.amdgcn_target "amdgcn-amd-amdhsa--gfx950"
.text
.globl gated_mix__softmax_full_mha__dense_activation_mish__prompt_kernel
.p2align 8
.type gated_mix__softmax_full_mha__dense_activation_mish__prompt_kernel,@function
gated_mix__softmax_full_mha__dense_activation_mish__prompt_kernel:
    s_cmp_ge_u32 s2, 256
    s_cbranch_scc1 L_end
    s_load_dwordx16 s[60:75], s[0:1], 0
    s_load_dwordx4 s[76:79], s[0:1], 64
    s_load_dwordx2 s[80:81], s[0:1], 80
    v_lshrrev_b32 v1, 6, v0
    v_and_b32 v0, 63, v0
    s_and_b32 s36, s2, 7
    s_lshr_b32 s37, s2, 3
    v_readfirstlane_b32 s41, v1
    v_lshlrev_b32 v1, 4, v0
    s_and_b32 s48, s36, 1
    s_lshr_b32 s49, s36, 1
    s_and_b32 s38, s37, 7
    s_lshl3_add_u32 s38, s48, s38
    s_lshr_b32 s39, s37, 3
    s_lshr_b32 s40, s39, 1
    s_and_b32 s39, s39, 1
    s_lshl1_add_u32 s39, s49, s39
    s_mul_i32 s50, s39, 3
    s_add_u32 s50, s50, 32
    s_and_b32 s51, s39, 1
    s_add_u32 s42, s50, s51
    s_lshl_b32 s51, s51, 1
    s_sub_u32 s43, s50, s51
    s_add_u32 s43, s43, 2
    s_lshl_b32 s50, s39, 2
    s_add_u32 s51, s50, 2
    s_cmp_eq_u32 s40, 0
    s_cselect_b32 s42, s42, s50
    s_cselect_b32 s43, s43, s51
    s_and_b32 s48, s37, 3
    s_lshl2_add_u32 s44, s36, s48
    s_lshr_b32 s45, s37, 2
    s_lshr_b32 s48, s37, 3
    s_lshl2_add_u32 s46, s36, s48
    s_and_b32 s47, s37, 7
    s_cmp_ge_u32 s41, 4
    s_cbranch_scc1 L_loader
    s_waitcnt lgkmcnt(0)
    s_mov_b32 s16, s80
    s_and_b32 s17, s81, 0xffff
    s_mov_b32 s18, 0x1800000
    s_mov_b32 s19, 0x00020000
    s_mov_b32 s24, s78
    s_and_b32 s25, s79, 0xffff
    s_mov_b32 s26, 0x100
    s_mov_b32 s27, 0x00020000
    s_mov_b32 s28, s74
    s_and_b32 s29, s75, 0xffff
    s_mov_b32 s30, 0x400
    s_mov_b32 s31, 0x00020000
    s_cmp_lg_u32 s41, 2
    s_cbranch_scc1 L_nogw
    s_cmp_eq_u32 s40, 0
    s_cbranch_scc1 L_nogw
    s_mov_b32 m0, 106496
    s_nop 0
    buffer_load_dwordx4 v1, s[28:31], 0 offen lds
L_nogw:
    v_lshrrev_b32 v2, 5, v0
    v_and_b32 v7, 31, v0
    v_bfe_u32 v3, v0, 1, 3
    v_xor_b32 v3, v3, v2
    v_lshlrev_b32 v3, 4, v3
    v_lshl_add_u32 v3, v7, 7, v3
    s_and_b32 s48, s41, 3
    s_xor_b32 s49, s48, 1
    s_lshl_b32 s48, s48, 12
    s_lshl_b32 s49, s49, 12
    v_add_u32 v50, s48, v3
    v_add_u32 v54, s49, v3
    v_xor_b32 v51, 32, v50
    v_xor_b32 v55, 32, v54
    v_xor_b32 v52, 64, v50
    v_xor_b32 v56, 64, v54
    v_xor_b32 v53, 96, v50
    v_xor_b32 v57, 96, v54
    v_bfe_u32 v4, v0, 2, 2
    v_and_b32 v5, 3, v0
    v_bfe_u32 v6, v0, 4, 1
    v_lshlrev_b32 v4, 6, v4
    v_lshl_add_u32 v4, v5, 3, v4
    v_lshl_add_u32 v4, v6, 5, v4
    v_lshl_add_u32 v4, v2, 10, v4
    s_and_b32 s48, s41, 1
    s_lshl_b32 s48, s48, 9
    v_add_u32 v58, s48, v4
    v_add_u32 v40, 0, v50
    v_add_u32 v41, 0, v51
    v_add_u32 v42, 0, v52
    v_add_u32 v43, 0, v53
    v_add_u32 v44, 0, v54
    v_add_u32 v45, 0, v55
    v_add_u32 v46, 0, v56
    v_add_u32 v47, 0, v57
    v_add_u32 v48, 147456, v58
    v_and_b32 v5, 15, v0
    v_lshlrev_b32 v5, 4, v5
    v_lshl_add_u32 v5, v2, 8, v5
    v_lshl_add_u32 v164, v6, 16, v5
    v_lshlrev_b32 v59, 4, v2
    v_add_u32 v59, 106496, v59
    s_lshr_b32 s50, s37, 3
    s_xor_b32 s50, s50, s37
    s_and_b32 s50, s50, 7
    s_lshl_b32 s48, s50, 7
    v_add_u32 v49, s48, v59
    s_lshl2_add_u32 s52, s38, s41
    s_xor_b32 s53, s52, 1
    s_and_b32 s51, s41, 1
    s_lshl1_add_u32 s51, s39, s51
    s_lshl_b32 s51, s51, 17
    s_mov_b32 s100, 0x3eb8aa3b
    s_mov_b32 s101, 0x3eb8aa3b
    v_mov_b32 v60, 0
    v_mov_b32 v61, 0
    v_mov_b32 v62, 0
    v_mov_b32 v63, 0
    v_mov_b32 v64, 0
    v_mov_b32 v65, 0
    v_mov_b32 v66, 0
    v_mov_b32 v67, 0
    v_mov_b32 v68, 0
    v_mov_b32 v69, 0
    v_mov_b32 v70, 0
    v_mov_b32 v71, 0
    v_mov_b32 v72, 0
    v_mov_b32 v73, 0
    v_mov_b32 v74, 0
    v_mov_b32 v75, 0
    v_mov_b32 v76, 0
    v_mov_b32 v77, 0
    v_mov_b32 v78, 0
    v_mov_b32 v79, 0
    v_mov_b32 v80, 0
    v_mov_b32 v81, 0
    v_mov_b32 v82, 0
    v_mov_b32 v83, 0
    v_mov_b32 v84, 0
    v_mov_b32 v85, 0
    v_mov_b32 v86, 0
    v_mov_b32 v87, 0
    v_mov_b32 v88, 0
    v_mov_b32 v89, 0
    v_mov_b32 v90, 0
    v_mov_b32 v91, 0
    v_mov_b32 v92, 0
    v_mov_b32 v93, 0
    v_mov_b32 v94, 0
    v_mov_b32 v95, 0
    v_mov_b32 v96, 0
    v_mov_b32 v97, 0
    v_mov_b32 v98, 0
    v_mov_b32 v99, 0
    v_mov_b32 v100, 0
    v_mov_b32 v101, 0
    v_mov_b32 v102, 0
    v_mov_b32 v103, 0
    v_mov_b32 v104, 0
    v_mov_b32 v105, 0
    v_mov_b32 v106, 0
    v_mov_b32 v107, 0
    v_mov_b32 v108, 0
    v_mov_b32 v109, 0
    v_mov_b32 v110, 0
    v_mov_b32 v111, 0
    v_mov_b32 v112, 0
    v_mov_b32 v113, 0
    v_mov_b32 v114, 0
    v_mov_b32 v115, 0
    v_mov_b32 v116, 0
    v_mov_b32 v117, 0
    v_mov_b32 v118, 0
    v_mov_b32 v119, 0
    v_mov_b32 v120, 0
    v_mov_b32 v121, 0
    v_mov_b32 v122, 0
    v_mov_b32 v123, 0
    s_waitcnt vmcnt(0)
    s_barrier
    s_cmp_lg_u32 s41, 1
    s_cbranch_scc1 L_cl_1
    s_lshl_b32 s48, s2, 9
    s_add_u32 s48, s48, 0xf00000
    v_lshlrev_b32 v2, 3, v0
    v_mov_b32 v6, 0
    v_mov_b32 v7, 0
    buffer_store_dwordx2 v[6:7], v2, s[16:19], s48 offen sc1
L_cl_1:
    s_cmp_eq_u32 s40, 0
    s_cbranch_scc0 L_compR
    ds_read_b128 v[124:127], v40
    ds_read_b64_tr_b16 v[132:133], v48 offset:0
    ds_read_b64_tr_b16 v[134:135], v48 offset:256
    ds_read_b128 v[128:131], v44
    ds_read_b64_tr_b16 v[136:137], v48 offset:8192
    ds_read_b64_tr_b16 v[138:139], v48 offset:8448
    ds_read_b128 v[140:143], v41
    ds_read_b64_tr_b16 v[148:149], v48 offset:2048
    ds_read_b64_tr_b16 v[150:151], v48 offset:2304
    ds_read_b128 v[144:147], v45
    ds_read_b64_tr_b16 v[152:153], v48 offset:10240
    ds_read_b64_tr_b16 v[154:155], v48 offset:10496
    s_mov_b32 s56, 0
    s_mov_b32 s58, 0x25410321
.p2align 3
L_loopP1:
    s_waitcnt lgkmcnt(6)
    v_mfma_f32_32x32x16_bf16 v[60:75], v[132:135], v[124:127], v[60:75]
    ds_read_b128 v[8:11], v42
    ds_read_b64_tr_b16 v[16:17], v48 offset:4096
    ds_read_b64_tr_b16 v[18:19], v48 offset:4352
    ds_read_b128 v[12:15], v46
    v_mfma_f32_32x32x16_bf16 v[76:91], v[132:135], v[128:131], v[76:91]
    ds_read_b64_tr_b16 v[20:21], v48 offset:12288
    ds_read_b64_tr_b16 v[22:23], v48 offset:12544
    s_add_u32 s56, s56, 1
    s_and_b32 s48, s58, 15
    v_mfma_f32_32x32x16_bf16 v[92:107], v[136:139], v[124:127], v[92:107]
    s_lshl_b32 s48, s48, 14
    s_lshr_b32 s58, s58, 4
    s_and_b32 s49, s56, 3
    s_sub_u32 s49, 9, s49
    v_mfma_f32_32x32x16_bf16 v[108:123], v[136:139], v[128:131], v[108:123]
    s_lshl_b32 s49, s49, 14
    s_waitcnt lgkmcnt(6)
    v_mfma_f32_32x32x16_bf16 v[60:75], v[148:151], v[140:143], v[60:75]
    ds_read_b128 v[24:27], v43
    ds_read_b64_tr_b16 v[32:33], v48 offset:6144
    v_mfma_f32_32x32x16_bf16 v[76:91], v[148:151], v[144:147], v[76:91]
    ds_read_b64_tr_b16 v[34:35], v48 offset:6400
    ds_read_b128 v[28:31], v47
    v_mfma_f32_32x32x16_bf16 v[92:107], v[152:155], v[140:143], v[92:107]
    ds_read_b64_tr_b16 v[36:37], v48 offset:14336
    ds_read_b64_tr_b16 v[38:39], v48 offset:14592
    v_mfma_f32_32x32x16_bf16 v[108:123], v[152:155], v[144:147], v[108:123]
    s_waitcnt lgkmcnt(6)
    v_mfma_f32_32x32x16_bf16 v[60:75], v[16:19], v[8:11], v[60:75]
    v_add_u32 v48, s49, v58
    v_add_u32 v40, s48, v50
    v_add_u32 v44, s48, v54
    v_mfma_f32_32x32x16_bf16 v[76:91], v[16:19], v[12:15], v[76:91]
    v_add_u32 v41, s48, v51
    v_add_u32 v45, s48, v55
    v_add_u32 v42, s48, v52
    v_mfma_f32_32x32x16_bf16 v[92:107], v[20:23], v[8:11], v[92:107]
    v_add_u32 v46, s48, v56
    v_add_u32 v43, s48, v53
    v_add_u32 v47, s48, v57
    v_mfma_f32_32x32x16_bf16 v[108:123], v[20:23], v[12:15], v[108:123]
    s_waitcnt lgkmcnt(0)
    s_barrier
    ds_read_b128 v[124:127], v40
    ds_read_b64_tr_b16 v[132:133], v48 offset:0
    ds_read_b64_tr_b16 v[134:135], v48 offset:256
    ds_read_b128 v[128:131], v44
    ds_read_b64_tr_b16 v[136:137], v48 offset:8192
    ds_read_b64_tr_b16 v[138:139], v48 offset:8448
    v_mfma_f32_32x32x16_bf16 v[60:75], v[32:35], v[24:27], v[60:75]
    ds_read_b128 v[140:143], v41
    ds_read_b64_tr_b16 v[148:149], v48 offset:2048
    v_mfma_f32_32x32x16_bf16 v[76:91], v[32:35], v[28:31], v[76:91]
    ds_read_b64_tr_b16 v[150:151], v48 offset:2304
    ds_read_b128 v[144:147], v45
    v_mfma_f32_32x32x16_bf16 v[92:107], v[36:39], v[24:27], v[92:107]
    ds_read_b64_tr_b16 v[152:153], v48 offset:10240
    ds_read_b64_tr_b16 v[154:155], v48 offset:10496
    v_mfma_f32_32x32x16_bf16 v[108:123], v[36:39], v[28:31], v[108:123]
    s_cmp_lt_u32 s56, 8
    s_cbranch_scc1 L_loopP1
    s_waitcnt lgkmcnt(0)
    s_nop 11
    v_cvt_pk_bf16_f32 v92, v92, v93
    v_cvt_pk_bf16_f32 v93, v94, v95
    v_cvt_pk_bf16_f32 v94, v96, v97
    v_cvt_pk_bf16_f32 v95, v98, v99
    v_cvt_pk_bf16_f32 v96, v100, v101
    v_cvt_pk_bf16_f32 v97, v102, v103
    v_cvt_pk_bf16_f32 v98, v104, v105
    v_cvt_pk_bf16_f32 v99, v106, v107
    s_lshl_b32 s48, s52, 10
    s_add_u32 s48, s48, s51
    s_add_u32 s48, s48, 0x200000
    s_add_u32 s49, s48, 0x10000
    buffer_store_dwordx4 v[92:95], v1, s[16:19], s48 offen sc1
    buffer_store_dwordx4 v[96:99], v1, s[16:19], s49 offen sc1
    v_cvt_pk_bf16_f32 v108, v108, v109
    v_cvt_pk_bf16_f32 v109, v110, v111
    v_cvt_pk_bf16_f32 v110, v112, v113
    v_cvt_pk_bf16_f32 v111, v114, v115
    v_cvt_pk_bf16_f32 v112, v116, v117
    v_cvt_pk_bf16_f32 v113, v118, v119
    v_cvt_pk_bf16_f32 v114, v120, v121
    v_cvt_pk_bf16_f32 v115, v122, v123
    s_lshl_b32 s48, s53, 10
    s_add_u32 s48, s48, s51
    s_add_u32 s48, s48, 0x200000
    s_add_u32 s49, s48, 0x10000
    buffer_store_dwordx4 v[108:111], v1, s[16:19], s48 offen sc1
    buffer_store_dwordx4 v[112:115], v1, s[16:19], s49 offen sc1
    s_barrier
    v_pk_mul_f32 v[60:61], v[60:61], s[100:101]
    v_pk_mul_f32 v[62:63], v[62:63], s[100:101]
    v_pk_mul_f32 v[64:65], v[64:65], s[100:101]
    v_pk_mul_f32 v[66:67], v[66:67], s[100:101]
    v_pk_mul_f32 v[68:69], v[68:69], s[100:101]
    v_pk_mul_f32 v[70:71], v[70:71], s[100:101]
    v_pk_mul_f32 v[72:73], v[72:73], s[100:101]
    v_pk_mul_f32 v[74:75], v[74:75], s[100:101]
    v_cvt_pk_bf16_f32 v60, v60, v61
    v_cvt_pk_bf16_f32 v61, v62, v63
    v_cvt_pk_bf16_f32 v62, v64, v65
    v_cvt_pk_bf16_f32 v63, v66, v67
    v_cvt_pk_bf16_f32 v64, v68, v69
    v_cvt_pk_bf16_f32 v65, v70, v71
    v_cvt_pk_bf16_f32 v66, v72, v73
    v_cvt_pk_bf16_f32 v67, v74, v75
    s_lshl_b32 s48, s52, 10
    s_add_u32 s48, s48, s51
    s_add_u32 s48, s48, 0x0
    s_add_u32 s49, s48, 0x10000
    buffer_store_dwordx4 v[60:63], v1, s[16:19], s48 offen sc1
    buffer_store_dwordx4 v[64:67], v1, s[16:19], s49 offen sc1
    v_pk_mul_f32 v[76:77], v[76:77], s[100:101]
    v_pk_mul_f32 v[78:79], v[78:79], s[100:101]
    v_pk_mul_f32 v[80:81], v[80:81], s[100:101]
    v_pk_mul_f32 v[82:83], v[82:83], s[100:101]
    v_pk_mul_f32 v[84:85], v[84:85], s[100:101]
    v_pk_mul_f32 v[86:87], v[86:87], s[100:101]
    v_pk_mul_f32 v[88:89], v[88:89], s[100:101]
    v_pk_mul_f32 v[90:91], v[90:91], s[100:101]
    v_cvt_pk_bf16_f32 v76, v76, v77
    v_cvt_pk_bf16_f32 v77, v78, v79
    v_cvt_pk_bf16_f32 v78, v80, v81
    v_cvt_pk_bf16_f32 v79, v82, v83
    v_cvt_pk_bf16_f32 v80, v84, v85
    v_cvt_pk_bf16_f32 v81, v86, v87
    v_cvt_pk_bf16_f32 v82, v88, v89
    v_cvt_pk_bf16_f32 v83, v90, v91
    s_lshl_b32 s48, s53, 10
    s_add_u32 s48, s48, s51
    s_add_u32 s48, s48, 0x0
    s_add_u32 s49, s48, 0x10000
    buffer_store_dwordx4 v[76:79], v1, s[16:19], s48 offen sc1
    buffer_store_dwordx4 v[80:83], v1, s[16:19], s49 offen sc1
    s_barrier
    s_barrier
    s_waitcnt vmcnt(0)
    s_barrier
    s_cmp_lg_u32 s41, 1
    s_cbranch_scc1 L_np_2
    v_lshlrev_b32 v2, 12, v0
    v_mov_b32 v3, 1
    s_lshl_b32 s48, s39, 9
    s_lshl4_add_u32 s49, s40, s38
    s_lshl2_add_u32 s48, s49, s48
    s_add_u32 s48, s48, 0xf00000
    s_mov_b64 exec, 0xffffffff
    buffer_store_dword v3, v2, s[16:19], s48 offen sc1
    s_mov_b64 exec, -1
L_np_2:
    s_barrier
    s_barrier
    s_barrier
    s_cmp_lg_u32 s41, 0
    s_cbranch_scc1 L_fl_3
    s_lshl_b32 s48, s2, 9
    s_add_u32 s48, s48, 0xf00000
    v_and_b32 v6, 31, v0
    v_lshlrev_b32 v6, 2, v6
    buffer_load_dword v18, v6, s[16:19], s48 offen sc1
L_fl_3:
    s_cmp_lg_u32 s41, 0
    s_cbranch_scc1 L_fc_4
    v_mov_b32 v2, 163784
    v_mov_b32 v3, 0
    ds_write_b32 v2, v3
    ds_write_b32 v2, v3 offset:4
    ds_write_b32 v2, v3 offset:8
    ds_write_b32 v2, v3 offset:12
    ds_write_b32 v2, v3 offset:16
    ds_write_b32 v2, v3 offset:20
    s_waitcnt lgkmcnt(0)
L_fc_4:
    s_barrier
    s_branch L_after_ab0
L_compR:
    ds_read_b128 v[124:127], v40
    ds_read_b64_tr_b16 v[132:133], v48 offset:0
    ds_read_b64_tr_b16 v[134:135], v48 offset:256
    ds_read_b128 v[128:131], v44
    ds_read_b128 v[136:139], v49 offset:0
    ds_read_b128 v[140:143], v41
    ds_read_b64_tr_b16 v[148:149], v48 offset:2048
    ds_read_b64_tr_b16 v[150:151], v48 offset:2304
    ds_read_b128 v[144:147], v45
    ds_read_b128 v[152:155], v49 offset:32
    s_mov_b32 s56, 0
    s_mov_b32 s58, 0x25410321
.p2align 3
L_loopR1:
    s_waitcnt lgkmcnt(5)
    v_mfma_f32_32x32x16_bf16 v[60:75], v[124:127], v[132:135], v[60:75]
    ds_read_b128 v[8:11], v42
    ds_read_b64_tr_b16 v[16:17], v48 offset:4096
    ds_read_b64_tr_b16 v[18:19], v48 offset:4352
    ds_read_b128 v[12:15], v46
    ds_read_b128 v[20:23], v49 offset:64
    v_mfma_f32_32x32x16_bf16 v[76:91], v[128:131], v[132:135], v[76:91]
    s_add_u32 s56, s56, 1
    s_and_b32 s48, s58, 15
    s_lshl_b32 s48, s48, 14
    s_lshr_b32 s58, s58, 4
    s_and_b32 s49, s56, 3
    v_mfma_f32_32x32x16_bf16 v[92:107], v[136:139], v[124:127], v[92:107]
    s_sub_u32 s49, 9, s49
    s_lshl_b32 s49, s49, 14
    s_xor_b32 s59, s56, s50
    s_and_b32 s59, s59, 7
    s_lshl_b32 s59, s59, 7
    s_waitcnt lgkmcnt(5)
    v_mfma_f32_32x32x16_bf16 v[60:75], v[140:143], v[148:151], v[60:75]
    ds_read_b128 v[24:27], v43
    ds_read_b64_tr_b16 v[32:33], v48 offset:6144
    v_mfma_f32_32x32x16_bf16 v[76:91], v[144:147], v[148:151], v[76:91]
    ds_read_b64_tr_b16 v[34:35], v48 offset:6400
    ds_read_b128 v[28:31], v47
    v_mfma_f32_32x32x16_bf16 v[92:107], v[152:155], v[140:143], v[92:107]
    ds_read_b128 v[36:39], v49 offset:96
    s_waitcnt lgkmcnt(5)
    v_mfma_f32_32x32x16_bf16 v[60:75], v[8:11], v[16:19], v[60:75]
    v_add_u32 v48, s49, v58
    v_add_u32 v40, s48, v50
    v_add_u32 v44, s48, v54
    v_add_u32 v41, s48, v51
    v_add_u32 v45, s48, v55
    v_mfma_f32_32x32x16_bf16 v[76:91], v[12:15], v[16:19], v[76:91]
    v_add_u32 v42, s48, v52
    v_add_u32 v46, s48, v56
    v_add_u32 v43, s48, v53
    v_add_u32 v47, s48, v57
    v_add_u32 v49, s59, v59
    v_mfma_f32_32x32x16_bf16 v[92:107], v[20:23], v[8:11], v[92:107]
    s_waitcnt lgkmcnt(0)
    s_barrier
    ds_read_b128 v[124:127], v40
    ds_read_b64_tr_b16 v[132:133], v48 offset:0
    ds_read_b64_tr_b16 v[134:135], v48 offset:256
    ds_read_b128 v[128:131], v44
    ds_read_b128 v[136:139], v49 offset:0
    v_mfma_f32_32x32x16_bf16 v[60:75], v[24:27], v[32:35], v[60:75]
    ds_read_b128 v[140:143], v41
    ds_read_b64_tr_b16 v[148:149], v48 offset:2048
    v_mfma_f32_32x32x16_bf16 v[76:91], v[28:31], v[32:35], v[76:91]
    ds_read_b64_tr_b16 v[150:151], v48 offset:2304
    ds_read_b128 v[144:147], v45
    v_mfma_f32_32x32x16_bf16 v[92:107], v[36:39], v[24:27], v[92:107]
    ds_read_b128 v[152:155], v49 offset:32
    s_cmp_lt_u32 s56, 8
    s_cbranch_scc1 L_loopR1
    s_waitcnt lgkmcnt(0)
    s_nop 11
    v_cvt_pk_bf16_f32 v60, v60, v61
    v_cvt_pk_bf16_f32 v61, v62, v63
    v_cvt_pk_bf16_f32 v62, v64, v65
    v_cvt_pk_bf16_f32 v63, v66, v67
    v_cvt_pk_bf16_f32 v64, v68, v69
    v_cvt_pk_bf16_f32 v65, v70, v71
    v_cvt_pk_bf16_f32 v66, v72, v73
    v_cvt_pk_bf16_f32 v67, v74, v75
    s_lshl_b32 s48, s52, 10
    s_add_u32 s48, s48, s51
    s_add_u32 s48, s48, 0x400000
    buffer_store_dwordx4 v[60:63], v164, s[16:19], s48 offen sc1
    buffer_store_dwordx4 v[64:67], v164, s[16:19], s48 offen offset:512 sc1
    s_barrier
    v_cvt_pk_bf16_f32 v76, v76, v77
    v_cvt_pk_bf16_f32 v77, v78, v79
    v_cvt_pk_bf16_f32 v78, v80, v81
    v_cvt_pk_bf16_f32 v79, v82, v83
    v_cvt_pk_bf16_f32 v80, v84, v85
    v_cvt_pk_bf16_f32 v81, v86, v87
    v_cvt_pk_bf16_f32 v82, v88, v89
    v_cvt_pk_bf16_f32 v83, v90, v91
    s_lshl_b32 s48, s53, 10
    s_add_u32 s48, s48, s51
    s_add_u32 s48, s48, 0x400000
    buffer_store_dwordx4 v[76:79], v164, s[16:19], s48 offen sc1
    buffer_store_dwordx4 v[80:83], v164, s[16:19], s48 offen offset:512 sc1
    v_mul_f32 v4, 0xbfb8aa3b, v92
    v_exp_f32 v4, v4
    v_and_b32 v6, 31, v0
    v_add_f32 v4, 1.0, v4
    v_rcp_f32 v4, v4
    v_lshlrev_b32 v6, 2, v6
    s_lshl_b32 s48, s39, 13
    s_lshl_b32 s49, s52, 7
    s_add_u32 s48, s48, s49
    s_add_u32 s48, s48, 0xe00000
    buffer_store_dword v4, v6, s[16:19], s48 offen sc1
    s_barrier
    s_barrier
    s_waitcnt vmcnt(0)
    s_barrier
    s_cmp_lg_u32 s41, 1
    s_cbranch_scc1 L_np_5
    v_lshlrev_b32 v2, 12, v0
    v_mov_b32 v3, 1
    s_lshl_b32 s48, s39, 9
    s_lshl4_add_u32 s49, s40, s38
    s_lshl2_add_u32 s48, s49, s48
    s_add_u32 s48, s48, 0xf00000
    s_mov_b64 exec, 0xffffffff
    buffer_store_dword v3, v2, s[16:19], s48 offen sc1
    s_mov_b64 exec, -1
L_np_5:
    s_barrier
    s_barrier
    s_barrier
    s_cmp_lg_u32 s41, 0
    s_cbranch_scc1 L_fl_6
    s_lshl_b32 s48, s2, 9
    s_add_u32 s48, s48, 0xf00000
    v_and_b32 v6, 31, v0
    v_lshlrev_b32 v6, 2, v6
    buffer_load_dword v18, v6, s[16:19], s48 offen sc1
L_fl_6:
    s_cmp_lg_u32 s41, 0
    s_cbranch_scc1 L_fc_7
    v_mov_b32 v2, 163784
    v_mov_b32 v3, 0
    ds_write_b32 v2, v3
    ds_write_b32 v2, v3 offset:4
    ds_write_b32 v2, v3 offset:8
    ds_write_b32 v2, v3 offset:12
    ds_write_b32 v2, v3 offset:16
    ds_write_b32 v2, v3 offset:20
    s_waitcnt lgkmcnt(0)
L_fc_7:
    s_barrier
    s_branch L_after_ab0
L_loader:
    s_and_b32 s50, s41, 3
    s_lshr_b32 s51, s41, 3
    v_lshrrev_b32 v4, 3, v0
    v_and_b32 v2, 7, v0
    v_lshrrev_b32 v3, 4, v0
    v_xor_b32 v2, v2, v3
    v_lshlrev_b32 v2, 4, v2
    v_lshl_add_u32 v8, v4, 10, v2
    v_xor_b32 v9, 64, v8
    v_bfe_u32 v4, v0, 2, 3
    v_lshrrev_b32 v2, 5, v0
    v_and_b32 v3, 3, v0
    v_lshlrev_b32 v3, 4, v3
    v_lshl_add_u32 v2, v2, 6, v3
    s_movk_i32 s48, 3072
    s_movk_i32 s49, 3584
    v_mad_u32_u24 v10, v4, s48, v2
    v_mad_u32_u24 v11, v4, s49, v2
    v_mad_u32_u24 v12, v4, s49, v3
    s_lshl_b32 s52, s38, 17
    s_lshl_b32 s48, s50, 15
    s_add_u32 s52, s52, s48
    s_mul_i32 s48, s50, 49152
    s_mul_i32 s49, s50, 57344
    s_lshl_b32 s53, s39, 7
    s_add_u32 s53, s53, s48
    s_lshl_b32 s55, s42, 6
    s_lshl_b32 s56, s43, 6
    s_add_u32 s55, s55, s49
    s_add_u32 s56, s56, s49
    s_lshl_b32 s58, s50, 12
    s_lshl_b32 s59, s50, 11
    s_lshr_b32 s57, s37, 3
    s_xor_b32 s57, s57, s37
    s_and_b32 s57, s57, 7
    s_cmp_eq_u32 s40, 0
    s_cbranch_scc0 L_loadR
    s_cmp_eq_u32 s51, 0
    s_cbranch_scc0 L_loadP1
    s_waitcnt lgkmcnt(0)
    s_mov_b32 s4, s60
    s_and_b32 s5, s61, 0xffff
    s_mov_b32 s6, 0x200000
    s_mov_b32 s7, 0x00020000
    s_mov_b32 s8, s62
    s_and_b32 s9, s63, 0xffff
    s_mov_b32 s10, 0x180000
    s_mov_b32 s11, 0x00020000
    s_xor_b32 s101, s57, 0
    s_lshl_b32 s49, s101, 7
    s_add_u32 s49, s49, s52
    s_mul_i32 s100, s101, 196608
    s_add_u32 m0, s58, 0
    s_add_u32 s48, s49, 0
    buffer_load_dwordx4 v8, s[4:7], s48 offen lds
    s_add_u32 m0, s58, 1024
    s_add_u32 s48, s49, 8192
    buffer_load_dwordx4 v9, s[4:7], s48 offen lds
    s_add_u32 m0, s58, 2048
    s_add_u32 s48, s49, 16384
    buffer_load_dwordx4 v8, s[4:7], s48 offen lds
    s_add_u32 m0, s58, 3072
    s_add_u32 s48, s49, 24576
    buffer_load_dwordx4 v9, s[4:7], s48 offen lds
    s_add_u32 s49, s100, s53
    s_add_u32 m0, s59, 147456
    s_add_u32 s48, s49, 0
    buffer_load_dwordx4 v10, s[8:11], s48 offen lds
    s_add_u32 m0, s59, 148480
    s_add_u32 s48, s49, 24576
    buffer_load_dwordx4 v10, s[8:11], s48 offen lds
    s_add_u32 s49, s100, s53
    s_add_u32 m0, s59, 155648
    s_add_u32 s48, s49, 1024
    buffer_load_dwordx4 v10, s[8:11], s48 offen lds
    s_add_u32 m0, s59, 156672
    s_add_u32 s48, s49, 25600
    buffer_load_dwordx4 v10, s[8:11], s48 offen lds
    s_mov_b32 s12, s68
    s_and_b32 s13, s69, 0xffff
    s_mov_b32 s14, 0x1c0000
    s_mov_b32 s15, 0x00020000
    s_mov_b32 s16, s80
    s_and_b32 s17, s81, 0xffff
    s_mov_b32 s18, 0x1800000
    s_mov_b32 s19, 0x00020000
    s_mov_b32 s24, s78
    s_and_b32 s25, s79, 0xffff
    s_mov_b32 s26, 0x100
    s_mov_b32 s27, 0x00020000
    v_lshrrev_b32 v2, 5, v0
    v_and_b32 v7, 31, v0
    v_bfe_u32 v3, v0, 1, 3
    v_xor_b32 v3, v3, v2
    v_lshlrev_b32 v3, 4, v3
    v_lshl_add_u32 v3, v7, 7, v3
    s_and_b32 s48, s41, 3
    s_xor_b32 s49, s48, 1
    s_lshl_b32 s48, s48, 12
    s_lshl_b32 s49, s49, 12
    v_add_u32 v50, s48, v3
    v_add_u32 v54, s49, v3
    v_xor_b32 v51, 32, v50
    v_xor_b32 v55, 32, v54
    v_xor_b32 v52, 64, v50
    v_xor_b32 v56, 64, v54
    v_xor_b32 v53, 96, v50
    v_xor_b32 v57, 96, v54
    v_bfe_u32 v4, v0, 2, 2
    v_and_b32 v5, 3, v0
    v_bfe_u32 v6, v0, 4, 1
    v_lshlrev_b32 v4, 6, v4
    v_lshl_add_u32 v4, v5, 3, v4
    v_lshl_add_u32 v4, v6, 5, v4
    v_lshl_add_u32 v4, v2, 10, v4
    s_and_b32 s48, s41, 1
    s_lshl_b32 s48, s48, 9
    v_add_u32 v58, s48, v4
    v_add_u32 v40, 32768, v50
    v_add_u32 v41, 32768, v51
    v_add_u32 v42, 32768, v52
    v_add_u32 v43, 32768, v53
    v_add_u32 v44, 32768, v54
    v_add_u32 v45, 32768, v55
    v_add_u32 v46, 32768, v56
    v_add_u32 v47, 32768, v57
    v_add_u32 v48, 147456, v58
    s_waitcnt vmcnt(0)
    s_barrier
    s_xor_b32 s101, s57, 2
    s_lshl_b32 s49, s101, 7
    s_add_u32 s49, s49, s52
    s_mul_i32 s100, s101, 196608
    s_add_u32 m0, s58, 32768
    s_add_u32 s48, s49, 0
    buffer_load_dwordx4 v8, s[4:7], s48 offen lds
    s_add_u32 m0, s58, 33792
    s_add_u32 s48, s49, 8192
    buffer_load_dwordx4 v9, s[4:7], s48 offen lds
    s_add_u32 m0, s58, 34816
    s_add_u32 s48, s49, 16384
    buffer_load_dwordx4 v8, s[4:7], s48 offen lds
    s_add_u32 m0, s58, 35840
    s_add_u32 s48, s49, 24576
    buffer_load_dwordx4 v9, s[4:7], s48 offen lds
    s_add_u32 s49, s100, s53
    s_add_u32 m0, s59, 114688
    s_add_u32 s48, s49, 0
    buffer_load_dwordx4 v10, s[8:11], s48 offen lds
    s_add_u32 m0, s59, 115712
    s_add_u32 s48, s49, 24576
    buffer_load_dwordx4 v10, s[8:11], s48 offen lds
    s_add_u32 s49, s100, s53
    s_add_u32 m0, s59, 122880
    s_add_u32 s48, s49, 1024
    buffer_load_dwordx4 v10, s[8:11], s48 offen lds
    s_add_u32 m0, s59, 123904
    s_add_u32 s48, s49, 25600
    buffer_load_dwordx4 v10, s[8:11], s48 offen lds
    s_barrier
    s_xor_b32 s101, s57, 4
    s_lshl_b32 s49, s101, 7
    s_add_u32 s49, s49, s52
    s_mul_i32 s100, s101, 196608
    s_add_u32 m0, s58, 0
    s_add_u32 s48, s49, 0
    buffer_load_dwordx4 v8, s[4:7], s48 offen lds
    s_add_u32 m0, s58, 1024
    s_add_u32 s48, s49, 8192
    buffer_load_dwordx4 v9, s[4:7], s48 offen lds
    s_add_u32 m0, s58, 2048
    s_add_u32 s48, s49, 16384
    buffer_load_dwordx4 v8, s[4:7], s48 offen lds
    s_add_u32 m0, s58, 3072
    s_add_u32 s48, s49, 24576
    buffer_load_dwordx4 v9, s[4:7], s48 offen lds
    s_add_u32 s49, s100, s53
    s_add_u32 m0, s59, 147456
    s_add_u32 s48, s49, 0
    buffer_load_dwordx4 v10, s[8:11], s48 offen lds
    s_add_u32 m0, s59, 148480
    s_add_u32 s48, s49, 24576
    buffer_load_dwordx4 v10, s[8:11], s48 offen lds
    s_add_u32 s49, s100, s53
    s_add_u32 m0, s59, 155648
    s_add_u32 s48, s49, 1024
    buffer_load_dwordx4 v10, s[8:11], s48 offen lds
    s_add_u32 m0, s59, 156672
    s_add_u32 s48, s49, 25600
    buffer_load_dwordx4 v10, s[8:11], s48 offen lds
    s_waitcnt vmcnt(8)
    s_barrier
    s_barrier
    s_xor_b32 s101, s57, 6
    s_lshl_b32 s49, s101, 7
    s_add_u32 s49, s49, s52
    s_mul_i32 s100, s101, 196608
    s_add_u32 m0, s58, 65536
    s_add_u32 s48, s49, 0
    buffer_load_dwordx4 v8, s[4:7], s48 offen lds
    s_add_u32 m0, s58, 66560
    s_add_u32 s48, s49, 8192
    buffer_load_dwordx4 v9, s[4:7], s48 offen lds
    s_add_u32 m0, s58, 67584
    s_add_u32 s48, s49, 16384
    buffer_load_dwordx4 v8, s[4:7], s48 offen lds
    s_add_u32 m0, s58, 68608
    s_add_u32 s48, s49, 24576
    buffer_load_dwordx4 v9, s[4:7], s48 offen lds
    s_add_u32 s49, s100, s53
    s_add_u32 m0, s59, 114688
    s_add_u32 s48, s49, 0
    buffer_load_dwordx4 v10, s[8:11], s48 offen lds
    s_add_u32 m0, s59, 115712
    s_add_u32 s48, s49, 24576
    buffer_load_dwordx4 v10, s[8:11], s48 offen lds
    s_add_u32 s49, s100, s53
    s_add_u32 m0, s59, 122880
    s_add_u32 s48, s49, 1024
    buffer_load_dwordx4 v10, s[8:11], s48 offen lds
    s_add_u32 m0, s59, 123904
    s_add_u32 s48, s49, 25600
    buffer_load_dwordx4 v10, s[8:11], s48 offen lds
    s_waitcnt vmcnt(8)
    s_barrier
    s_mov_b32 s20, s70
    s_and_b32 s21, s71, 0xffff
    s_mov_b32 s22, 0xe00
    s_mov_b32 s23, 0x00020000
    v_lshrrev_b32 v2, 5, v0
    v_lshlrev_b32 v2, 3, v2
    s_and_b32 s100, s41, 1
    s_add_u32 s48, s42, s100
    s_mul_i32 s49, s100, s40
    s_add_u32 s49, s49, s43
    s_lshl_b32 s48, s48, 6
    s_lshl_b32 s49, s49, 6
    buffer_load_dwordx2 v[124:125], v2, s[20:23], s48 offen offset:0
    buffer_load_dwordx2 v[126:127], v2, s[20:23], s48 offen offset:16
    buffer_load_dwordx2 v[128:129], v2, s[20:23], s48 offen offset:32
    buffer_load_dwordx2 v[130:131], v2, s[20:23], s48 offen offset:48
    buffer_load_dwordx2 v[132:133], v2, s[20:23], s49 offen offset:0
    buffer_load_dwordx2 v[134:135], v2, s[20:23], s49 offen offset:16
    buffer_load_dwordx2 v[136:137], v2, s[20:23], s49 offen offset:32
    buffer_load_dwordx2 v[138:139], v2, s[20:23], s49 offen offset:48
    s_barrier
    s_xor_b32 s101, s57, 2
    s_lshl_b32 s49, s101, 7
    s_add_u32 s49, s49, s52
    s_mul_i32 s100, s101, 229376
    s_add_u32 s49, s100, s55
    s_add_u32 m0, s59, 147456
    s_add_u32 s48, s49, 0
    buffer_load_dwordx4 v11, s[12:15], s48 offen lds
    s_add_u32 m0, s59, 148480
    s_add_u32 s48, s49, 28672
    buffer_load_dwordx4 v11, s[12:15], s48 offen lds
    s_add_u32 s49, s100, s56
    s_add_u32 m0, s59, 155648
    s_add_u32 s48, s49, 0
    buffer_load_dwordx4 v12, s[12:15], s48 offen lds
    s_add_u32 m0, s59, 156672
    s_add_u32 s48, s49, 28672
    buffer_load_dwordx4 v12, s[12:15], s48 offen lds
    s_waitcnt vmcnt(12)
    s_barrier
    s_waitcnt vmcnt(4)
    v_lshlrev_b32 v60, 16, v124
    v_and_b32 v61, 0xffff0000, v124
    v_lshlrev_b32 v62, 16, v125
    v_and_b32 v63, 0xffff0000, v125
    v_lshlrev_b32 v76, 16, v124
    v_and_b32 v77, 0xffff0000, v124
    v_lshlrev_b32 v78, 16, v125
    v_and_b32 v79, 0xffff0000, v125
    v_lshlrev_b32 v64, 16, v126
    v_and_b32 v65, 0xffff0000, v126
    v_lshlrev_b32 v66, 16, v127
    v_and_b32 v67, 0xffff0000, v127
    v_lshlrev_b32 v80, 16, v126
    v_and_b32 v81, 0xffff0000, v126
    v_lshlrev_b32 v82, 16, v127
    v_and_b32 v83, 0xffff0000, v127
    v_lshlrev_b32 v68, 16, v128
    v_and_b32 v69, 0xffff0000, v128
    v_lshlrev_b32 v70, 16, v129
    v_and_b32 v71, 0xffff0000, v129
    v_lshlrev_b32 v84, 16, v128
    v_and_b32 v85, 0xffff0000, v128
    v_lshlrev_b32 v86, 16, v129
    v_and_b32 v87, 0xffff0000, v129
    v_lshlrev_b32 v72, 16, v130
    v_and_b32 v73, 0xffff0000, v130
    v_lshlrev_b32 v74, 16, v131
    v_and_b32 v75, 0xffff0000, v131
    v_lshlrev_b32 v88, 16, v130
    v_and_b32 v89, 0xffff0000, v130
    v_lshlrev_b32 v90, 16, v131
    v_and_b32 v91, 0xffff0000, v131
    v_lshlrev_b32 v92, 16, v132
    v_and_b32 v93, 0xffff0000, v132
    v_lshlrev_b32 v94, 16, v133
    v_and_b32 v95, 0xffff0000, v133
    v_lshlrev_b32 v108, 16, v132
    v_and_b32 v109, 0xffff0000, v132
    v_lshlrev_b32 v110, 16, v133
    v_and_b32 v111, 0xffff0000, v133
    v_lshlrev_b32 v96, 16, v134
    v_and_b32 v97, 0xffff0000, v134
    v_lshlrev_b32 v98, 16, v135
    v_and_b32 v99, 0xffff0000, v135
    v_lshlrev_b32 v112, 16, v134
    v_and_b32 v113, 0xffff0000, v134
    v_lshlrev_b32 v114, 16, v135
    v_and_b32 v115, 0xffff0000, v135
    v_lshlrev_b32 v100, 16, v136
    v_and_b32 v101, 0xffff0000, v136
    v_lshlrev_b32 v102, 16, v137
    v_and_b32 v103, 0xffff0000, v137
    v_lshlrev_b32 v116, 16, v136
    v_and_b32 v117, 0xffff0000, v136
    v_lshlrev_b32 v118, 16, v137
    v_and_b32 v119, 0xffff0000, v137
    v_lshlrev_b32 v104, 16, v138
    v_and_b32 v105, 0xffff0000, v138
    v_lshlrev_b32 v106, 16, v139
    v_and_b32 v107, 0xffff0000, v139
    v_lshlrev_b32 v120, 16, v138
    v_and_b32 v121, 0xffff0000, v138
    v_lshlrev_b32 v122, 16, v139
    v_and_b32 v123, 0xffff0000, v139
    s_barrier
    s_waitcnt vmcnt(0)
    s_barrier
    s_branch L_pass2P
L_loadP1:
    s_waitcnt lgkmcnt(0)
    s_mov_b32 s4, s60
    s_and_b32 s5, s61, 0xffff
    s_mov_b32 s6, 0x200000
    s_mov_b32 s7, 0x00020000
    s_mov_b32 s8, s62
    s_and_b32 s9, s63, 0xffff
    s_mov_b32 s10, 0x180000
    s_mov_b32 s11, 0x00020000
    s_xor_b32 s101, s57, 1
    s_lshl_b32 s49, s101, 7
    s_add_u32 s49, s49, s52
    s_mul_i32 s100, s101, 196608
    s_add_u32 m0, s58, 16384
    s_add_u32 s48, s49, 0
    buffer_load_dwordx4 v8, s[4:7], s48 offen lds
    s_add_u32 m0, s58, 17408
    s_add_u32 s48, s49, 8192
    buffer_load_dwordx4 v9, s[4:7], s48 offen lds
    s_add_u32 m0, s58, 18432
    s_add_u32 s48, s49, 16384
    buffer_load_dwordx4 v8, s[4:7], s48 offen lds
    s_add_u32 m0, s58, 19456
    s_add_u32 s48, s49, 24576
    buffer_load_dwordx4 v9, s[4:7], s48 offen lds
    s_add_u32 s49, s100, s53
    s_add_u32 m0, s59, 131072
    s_add_u32 s48, s49, 0
    buffer_load_dwordx4 v10, s[8:11], s48 offen lds
    s_add_u32 m0, s59, 132096
    s_add_u32 s48, s49, 24576
    buffer_load_dwordx4 v10, s[8:11], s48 offen lds
    s_add_u32 s49, s100, s53
    s_add_u32 m0, s59, 139264
    s_add_u32 s48, s49, 1024
    buffer_load_dwordx4 v10, s[8:11], s48 offen lds
    s_add_u32 m0, s59, 140288
    s_add_u32 s48, s49, 25600
    buffer_load_dwordx4 v10, s[8:11], s48 offen lds
    s_mov_b32 s12, s68
    s_and_b32 s13, s69, 0xffff
    s_mov_b32 s14, 0x1c0000
    s_mov_b32 s15, 0x00020000
    s_mov_b32 s16, s80
    s_and_b32 s17, s81, 0xffff
    s_mov_b32 s18, 0x1800000
    s_mov_b32 s19, 0x00020000
    s_mov_b32 s24, s78
    s_and_b32 s25, s79, 0xffff
    s_mov_b32 s26, 0x100
    s_mov_b32 s27, 0x00020000
    s_barrier
    s_xor_b32 s101, s57, 3
    s_lshl_b32 s49, s101, 7
    s_add_u32 s49, s49, s52
    s_mul_i32 s100, s101, 196608
    s_add_u32 m0, s58, 49152
    s_add_u32 s48, s49, 0
    buffer_load_dwordx4 v8, s[4:7], s48 offen lds
    s_add_u32 m0, s58, 50176
    s_add_u32 s48, s49, 8192
    buffer_load_dwordx4 v9, s[4:7], s48 offen lds
    s_add_u32 m0, s58, 51200
    s_add_u32 s48, s49, 16384
    buffer_load_dwordx4 v8, s[4:7], s48 offen lds
    s_add_u32 m0, s58, 52224
    s_add_u32 s48, s49, 24576
    buffer_load_dwordx4 v9, s[4:7], s48 offen lds
    s_add_u32 s49, s100, s53
    s_add_u32 m0, s59, 98304
    s_add_u32 s48, s49, 0
    buffer_load_dwordx4 v10, s[8:11], s48 offen lds
    s_add_u32 m0, s59, 99328
    s_add_u32 s48, s49, 24576
    buffer_load_dwordx4 v10, s[8:11], s48 offen lds
    s_add_u32 s49, s100, s53
    s_add_u32 m0, s59, 106496
    s_add_u32 s48, s49, 1024
    buffer_load_dwordx4 v10, s[8:11], s48 offen lds
    s_add_u32 m0, s59, 107520
    s_add_u32 s48, s49, 25600
    buffer_load_dwordx4 v10, s[8:11], s48 offen lds
    s_waitcnt vmcnt(8)
    s_barrier
    s_barrier
    s_xor_b32 s101, s57, 5
    s_lshl_b32 s49, s101, 7
    s_add_u32 s49, s49, s52
    s_mul_i32 s100, s101, 196608
    s_add_u32 m0, s58, 16384
    s_add_u32 s48, s49, 0
    buffer_load_dwordx4 v8, s[4:7], s48 offen lds
    s_add_u32 m0, s58, 17408
    s_add_u32 s48, s49, 8192
    buffer_load_dwordx4 v9, s[4:7], s48 offen lds
    s_add_u32 m0, s58, 18432
    s_add_u32 s48, s49, 16384
    buffer_load_dwordx4 v8, s[4:7], s48 offen lds
    s_add_u32 m0, s58, 19456
    s_add_u32 s48, s49, 24576
    buffer_load_dwordx4 v9, s[4:7], s48 offen lds
    s_add_u32 s49, s100, s53
    s_add_u32 m0, s59, 131072
    s_add_u32 s48, s49, 0
    buffer_load_dwordx4 v10, s[8:11], s48 offen lds
    s_add_u32 m0, s59, 132096
    s_add_u32 s48, s49, 24576
    buffer_load_dwordx4 v10, s[8:11], s48 offen lds
    s_add_u32 s49, s100, s53
    s_add_u32 m0, s59, 139264
    s_add_u32 s48, s49, 1024
    buffer_load_dwordx4 v10, s[8:11], s48 offen lds
    s_add_u32 m0, s59, 140288
    s_add_u32 s48, s49, 25600
    buffer_load_dwordx4 v10, s[8:11], s48 offen lds
    s_waitcnt vmcnt(8)
    s_barrier
    s_barrier
    s_xor_b32 s101, s57, 7
    s_lshl_b32 s49, s101, 7
    s_add_u32 s49, s49, s52
    s_mul_i32 s100, s101, 196608
    s_add_u32 m0, s58, 81920
    s_add_u32 s48, s49, 0
    buffer_load_dwordx4 v8, s[4:7], s48 offen lds
    s_add_u32 m0, s58, 82944
    s_add_u32 s48, s49, 8192
    buffer_load_dwordx4 v9, s[4:7], s48 offen lds
    s_add_u32 m0, s58, 83968
    s_add_u32 s48, s49, 16384
    buffer_load_dwordx4 v8, s[4:7], s48 offen lds
    s_add_u32 m0, s58, 84992
    s_add_u32 s48, s49, 24576
    buffer_load_dwordx4 v9, s[4:7], s48 offen lds
    s_add_u32 s49, s100, s53
    s_add_u32 m0, s59, 98304
    s_add_u32 s48, s49, 0
    buffer_load_dwordx4 v10, s[8:11], s48 offen lds
    s_add_u32 m0, s59, 99328
    s_add_u32 s48, s49, 24576
    buffer_load_dwordx4 v10, s[8:11], s48 offen lds
    s_add_u32 s49, s100, s53
    s_add_u32 m0, s59, 106496
    s_add_u32 s48, s49, 1024
    buffer_load_dwordx4 v10, s[8:11], s48 offen lds
    s_add_u32 m0, s59, 107520
    s_add_u32 s48, s49, 25600
    buffer_load_dwordx4 v10, s[8:11], s48 offen lds
    s_waitcnt vmcnt(8)
    s_barrier
    s_barrier
    s_xor_b32 s101, s57, 3
    s_lshl_b32 s49, s101, 7
    s_add_u32 s49, s49, s52
    s_mul_i32 s100, s101, 229376
    s_add_u32 s49, s100, s55
    s_add_u32 m0, s59, 131072
    s_add_u32 s48, s49, 0
    buffer_load_dwordx4 v11, s[12:15], s48 offen lds
    s_add_u32 m0, s59, 132096
    s_add_u32 s48, s49, 28672
    buffer_load_dwordx4 v11, s[12:15], s48 offen lds
    s_add_u32 s49, s100, s56
    s_add_u32 m0, s59, 139264
    s_add_u32 s48, s49, 0
    buffer_load_dwordx4 v12, s[12:15], s48 offen lds
    s_add_u32 m0, s59, 140288
    s_add_u32 s48, s49, 28672
    buffer_load_dwordx4 v12, s[12:15], s48 offen lds
    s_waitcnt vmcnt(4)
    s_barrier
    s_xor_b32 s101, s57, 4
    s_lshl_b32 s49, s101, 7
    s_add_u32 s49, s49, s52
    s_mul_i32 s100, s101, 229376
    s_add_u32 s49, s100, s55
    s_add_u32 m0, s59, 114688
    s_add_u32 s48, s49, 0
    buffer_load_dwordx4 v11, s[12:15], s48 offen lds
    s_add_u32 m0, s59, 115712
    s_add_u32 s48, s49, 28672
    buffer_load_dwordx4 v11, s[12:15], s48 offen lds
    s_add_u32 s49, s100, s56
    s_add_u32 m0, s59, 122880
    s_add_u32 s48, s49, 0
    buffer_load_dwordx4 v12, s[12:15], s48 offen lds
    s_add_u32 m0, s59, 123904
    s_add_u32 s48, s49, 28672
    buffer_load_dwordx4 v12, s[12:15], s48 offen lds
    s_barrier
    s_xor_b32 s101, s57, 5
    s_lshl_b32 s49, s101, 7
    s_add_u32 s49, s49, s52
    s_mul_i32 s100, s101, 229376
    s_add_u32 s49, s100, s55
    s_add_u32 m0, s59, 98304
    s_add_u32 s48, s49, 0
    buffer_load_dwordx4 v11, s[12:15], s48 offen lds
    s_add_u32 m0, s59, 99328
    s_add_u32 s48, s49, 28672
    buffer_load_dwordx4 v11, s[12:15], s48 offen lds
    s_add_u32 s49, s100, s56
    s_add_u32 m0, s59, 106496
    s_add_u32 s48, s49, 0
    buffer_load_dwordx4 v12, s[12:15], s48 offen lds
    s_add_u32 m0, s59, 107520
    s_add_u32 s48, s49, 28672
    buffer_load_dwordx4 v12, s[12:15], s48 offen lds
    s_waitcnt vmcnt(8)
    s_barrier
    s_xor_b32 s101, s57, 6
    s_lshl_b32 s49, s101, 7
    s_add_u32 s49, s49, s52
    s_mul_i32 s100, s101, 229376
    s_add_u32 s49, s100, s55
    s_add_u32 m0, s59, 147456
    s_add_u32 s48, s49, 0
    buffer_load_dwordx4 v11, s[12:15], s48 offen lds
    s_add_u32 m0, s59, 148480
    s_add_u32 s48, s49, 28672
    buffer_load_dwordx4 v11, s[12:15], s48 offen lds
    s_add_u32 s49, s100, s56
    s_add_u32 m0, s59, 155648
    s_add_u32 s48, s49, 0
    buffer_load_dwordx4 v12, s[12:15], s48 offen lds
    s_add_u32 m0, s59, 156672
    s_add_u32 s48, s49, 28672
    buffer_load_dwordx4 v12, s[12:15], s48 offen lds
    s_waitcnt vmcnt(8)
    s_barrier
    s_xor_b32 s101, s57, 7
    s_lshl_b32 s49, s101, 7
    s_add_u32 s49, s49, s52
    s_mul_i32 s100, s101, 229376
    s_add_u32 s49, s100, s55
    s_add_u32 m0, s59, 131072
    s_add_u32 s48, s49, 0
    buffer_load_dwordx4 v11, s[12:15], s48 offen lds
    s_add_u32 m0, s59, 132096
    s_add_u32 s48, s49, 28672
    buffer_load_dwordx4 v11, s[12:15], s48 offen lds
    s_add_u32 s49, s100, s56
    s_add_u32 m0, s59, 139264
    s_add_u32 s48, s49, 0
    buffer_load_dwordx4 v12, s[12:15], s48 offen lds
    s_add_u32 m0, s59, 140288
    s_add_u32 s48, s49, 28672
    buffer_load_dwordx4 v12, s[12:15], s48 offen lds
    s_waitcnt vmcnt(8)
    s_barrier
    s_xor_b32 s101, s57, 0
    s_lshl_b32 s49, s101, 7
    s_add_u32 s49, s49, s52
    s_mul_i32 s100, s101, 229376
    s_add_u32 m0, s58, 0
    s_add_u32 s48, s49, 0
    buffer_load_dwordx4 v8, s[4:7], s48 offen lds
    s_add_u32 m0, s58, 1024
    s_add_u32 s48, s49, 8192
    buffer_load_dwordx4 v9, s[4:7], s48 offen lds
    s_add_u32 m0, s58, 2048
    s_add_u32 s48, s49, 16384
    buffer_load_dwordx4 v8, s[4:7], s48 offen lds
    s_add_u32 m0, s58, 3072
    s_add_u32 s48, s49, 24576
    buffer_load_dwordx4 v9, s[4:7], s48 offen lds
    s_add_u32 s49, s100, s55
    s_add_u32 m0, s59, 114688
    s_add_u32 s48, s49, 0
    buffer_load_dwordx4 v11, s[12:15], s48 offen lds
    s_add_u32 m0, s59, 115712
    s_add_u32 s48, s49, 28672
    buffer_load_dwordx4 v11, s[12:15], s48 offen lds
    s_add_u32 s49, s100, s56
    s_add_u32 m0, s59, 122880
    s_add_u32 s48, s49, 0
    buffer_load_dwordx4 v12, s[12:15], s48 offen lds
    s_add_u32 m0, s59, 123904
    s_add_u32 s48, s49, 28672
    buffer_load_dwordx4 v12, s[12:15], s48 offen lds
    s_waitcnt vmcnt(12)
    s_barrier
    s_xor_b32 s101, s57, 1
    s_lshl_b32 s49, s101, 7
    s_add_u32 s49, s49, s52
    s_mul_i32 s100, s101, 229376
    s_add_u32 m0, s58, 16384
    s_add_u32 s48, s49, 0
    buffer_load_dwordx4 v8, s[4:7], s48 offen lds
    s_add_u32 m0, s58, 17408
    s_add_u32 s48, s49, 8192
    buffer_load_dwordx4 v9, s[4:7], s48 offen lds
    s_add_u32 m0, s58, 18432
    s_add_u32 s48, s49, 16384
    buffer_load_dwordx4 v8, s[4:7], s48 offen lds
    s_add_u32 m0, s58, 19456
    s_add_u32 s48, s49, 24576
    buffer_load_dwordx4 v9, s[4:7], s48 offen lds
    s_add_u32 s49, s100, s55
    s_add_u32 m0, s59, 98304
    s_add_u32 s48, s49, 0
    buffer_load_dwordx4 v11, s[12:15], s48 offen lds
    s_add_u32 m0, s59, 99328
    s_add_u32 s48, s49, 28672
    buffer_load_dwordx4 v11, s[12:15], s48 offen lds
    s_add_u32 s49, s100, s56
    s_add_u32 m0, s59, 106496
    s_add_u32 s48, s49, 0
    buffer_load_dwordx4 v12, s[12:15], s48 offen lds
    s_add_u32 m0, s59, 107520
    s_add_u32 s48, s49, 28672
    buffer_load_dwordx4 v12, s[12:15], s48 offen lds
    s_waitcnt vmcnt(16)
    s_barrier
    s_waitcnt vmcnt(8)
    s_barrier
    s_waitcnt vmcnt(0)
    s_barrier
    s_barrier
    s_branch L_after_ab1
L_loadR:
    s_cmp_eq_u32 s51, 0
    s_cbranch_scc0 L_loadR1
    s_waitcnt lgkmcnt(0)
    s_mov_b32 s4, s60
    s_and_b32 s5, s61, 0xffff
    s_mov_b32 s6, 0x200000
    s_mov_b32 s7, 0x00020000
    s_mov_b32 s8, s62
    s_and_b32 s9, s63, 0xffff
    s_mov_b32 s10, 0x180000
    s_mov_b32 s11, 0x00020000
    s_xor_b32 s101, s57, 0
    s_lshl_b32 s49, s101, 7
    s_add_u32 s49, s49, s52
    s_mul_i32 s100, s101, 196608
    s_add_u32 m0, s58, 0
    s_add_u32 s48, s49, 0
    buffer_load_dwordx4 v8, s[4:7], s48 offen lds
    s_add_u32 m0, s58, 1024
    s_add_u32 s48, s49, 8192
    buffer_load_dwordx4 v9, s[4:7], s48 offen lds
    s_add_u32 m0, s58, 2048
    s_add_u32 s48, s49, 16384
    buffer_load_dwordx4 v8, s[4:7], s48 offen lds
    s_add_u32 m0, s58, 3072
    s_add_u32 s48, s49, 24576
    buffer_load_dwordx4 v9, s[4:7], s48 offen lds
    s_add_u32 s49, s100, s53
    s_add_u32 m0, s59, 147456
    s_add_u32 s48, s49, 2048
    buffer_load_dwordx4 v10, s[8:11], s48 offen lds
    s_add_u32 m0, s59, 148480
    s_add_u32 s48, s49, 26624
    buffer_load_dwordx4 v10, s[8:11], s48 offen lds
    s_mov_b32 s12, s68
    s_and_b32 s13, s69, 0xffff
    s_mov_b32 s14, 0x1c0000
    s_mov_b32 s15, 0x00020000
    s_mov_b32 s16, s80
    s_and_b32 s17, s81, 0xffff
    s_mov_b32 s18, 0x1800000
    s_mov_b32 s19, 0x00020000
    s_mov_b32 s24, s78
    s_and_b32 s25, s79, 0xffff
    s_mov_b32 s26, 0x100
    s_mov_b32 s27, 0x00020000
    v_lshrrev_b32 v2, 5, v0
    v_and_b32 v7, 31, v0
    v_bfe_u32 v3, v0, 1, 3
    v_xor_b32 v3, v3, v2
    v_lshlrev_b32 v3, 4, v3
    v_lshl_add_u32 v3, v7, 7, v3
    s_and_b32 s48, s41, 3
    s_xor_b32 s49, s48, 1
    s_lshl_b32 s48, s48, 12
    s_lshl_b32 s49, s49, 12
    v_add_u32 v50, s48, v3
    v_add_u32 v54, s49, v3
    v_xor_b32 v51, 32, v50
    v_xor_b32 v55, 32, v54
    v_xor_b32 v52, 64, v50
    v_xor_b32 v56, 64, v54
    v_xor_b32 v53, 96, v50
    v_xor_b32 v57, 96, v54
    v_bfe_u32 v4, v0, 2, 2
    v_and_b32 v5, 3, v0
    v_bfe_u32 v6, v0, 4, 1
    v_lshlrev_b32 v4, 6, v4
    v_lshl_add_u32 v4, v5, 3, v4
    v_lshl_add_u32 v4, v6, 5, v4
    v_lshl_add_u32 v4, v2, 10, v4
    s_and_b32 s48, s41, 1
    s_lshl_b32 s48, s48, 9
    v_add_u32 v58, s48, v4
    v_add_u32 v40, 32768, v50
    v_add_u32 v41, 32768, v51
    v_add_u32 v42, 32768, v52
    v_add_u32 v43, 32768, v53
    v_add_u32 v44, 32768, v54
    v_add_u32 v45, 32768, v55
    v_add_u32 v46, 32768, v56
    v_add_u32 v47, 32768, v57
    v_add_u32 v48, 147456, v58
    s_waitcnt vmcnt(0)
    s_barrier
    s_xor_b32 s101, s57, 2
    s_lshl_b32 s49, s101, 7
    s_add_u32 s49, s49, s52
    s_mul_i32 s100, s101, 196608
    s_add_u32 m0, s58, 32768
    s_add_u32 s48, s49, 0
    buffer_load_dwordx4 v8, s[4:7], s48 offen lds
    s_add_u32 m0, s58, 33792
    s_add_u32 s48, s49, 8192
    buffer_load_dwordx4 v9, s[4:7], s48 offen lds
    s_add_u32 m0, s58, 34816
    s_add_u32 s48, s49, 16384
    buffer_load_dwordx4 v8, s[4:7], s48 offen lds
    s_add_u32 m0, s58, 35840
    s_add_u32 s48, s49, 24576
    buffer_load_dwordx4 v9, s[4:7], s48 offen lds
    s_add_u32 s49, s100, s53
    s_add_u32 m0, s59, 114688
    s_add_u32 s48, s49, 2048
    buffer_load_dwordx4 v10, s[8:11], s48 offen lds
    s_add_u32 m0, s59, 115712
    s_add_u32 s48, s49, 26624
    buffer_load_dwordx4 v10, s[8:11], s48 offen lds
    s_barrier
    s_xor_b32 s101, s57, 4
    s_lshl_b32 s49, s101, 7
    s_add_u32 s49, s49, s52
    s_mul_i32 s100, s101, 196608
    s_add_u32 m0, s58, 0
    s_add_u32 s48, s49, 0
    buffer_load_dwordx4 v8, s[4:7], s48 offen lds
    s_add_u32 m0, s58, 1024
    s_add_u32 s48, s49, 8192
    buffer_load_dwordx4 v9, s[4:7], s48 offen lds
    s_add_u32 m0, s58, 2048
    s_add_u32 s48, s49, 16384
    buffer_load_dwordx4 v8, s[4:7], s48 offen lds
    s_add_u32 m0, s58, 3072
    s_add_u32 s48, s49, 24576
    buffer_load_dwordx4 v9, s[4:7], s48 offen lds
    s_add_u32 s49, s100, s53
    s_add_u32 m0, s59, 147456
    s_add_u32 s48, s49, 2048
    buffer_load_dwordx4 v10, s[8:11], s48 offen lds
    s_add_u32 m0, s59, 148480
    s_add_u32 s48, s49, 26624
    buffer_load_dwordx4 v10, s[8:11], s48 offen lds
    s_waitcnt vmcnt(6)
    s_barrier
    s_barrier
    s_xor_b32 s101, s57, 6
    s_lshl_b32 s49, s101, 7
    s_add_u32 s49, s49, s52
    s_mul_i32 s100, s101, 196608
    s_add_u32 m0, s58, 65536
    s_add_u32 s48, s49, 0
    buffer_load_dwordx4 v8, s[4:7], s48 offen lds
    s_add_u32 m0, s58, 66560
    s_add_u32 s48, s49, 8192
    buffer_load_dwordx4 v9, s[4:7], s48 offen lds
    s_add_u32 m0, s58, 67584
    s_add_u32 s48, s49, 16384
    buffer_load_dwordx4 v8, s[4:7], s48 offen lds
    s_add_u32 m0, s58, 68608
    s_add_u32 s48, s49, 24576
    buffer_load_dwordx4 v9, s[4:7], s48 offen lds
    s_add_u32 s49, s100, s53
    s_add_u32 m0, s59, 114688
    s_add_u32 s48, s49, 2048
    buffer_load_dwordx4 v10, s[8:11], s48 offen lds
    s_add_u32 m0, s59, 115712
    s_add_u32 s48, s49, 26624
    buffer_load_dwordx4 v10, s[8:11], s48 offen lds
    s_waitcnt vmcnt(6)
    s_barrier
    s_mov_b32 s20, s70
    s_and_b32 s21, s71, 0xffff
    s_mov_b32 s22, 0xe00
    s_mov_b32 s23, 0x00020000
    v_lshrrev_b32 v2, 5, v0
    v_lshlrev_b32 v2, 3, v2
    s_and_b32 s100, s41, 1
    s_add_u32 s48, s42, s100
    s_mul_i32 s49, s100, s40
    s_add_u32 s49, s49, s43
    s_lshl_b32 s48, s48, 6
    s_lshl_b32 s49, s49, 6
    buffer_load_dwordx2 v[124:125], v2, s[20:23], s48 offen offset:0
    buffer_load_dwordx2 v[126:127], v2, s[20:23], s48 offen offset:16
    buffer_load_dwordx2 v[128:129], v2, s[20:23], s48 offen offset:32
    buffer_load_dwordx2 v[130:131], v2, s[20:23], s48 offen offset:48
    buffer_load_dwordx2 v[132:133], v2, s[20:23], s49 offen offset:0
    buffer_load_dwordx2 v[134:135], v2, s[20:23], s49 offen offset:16
    buffer_load_dwordx2 v[136:137], v2, s[20:23], s49 offen offset:32
    buffer_load_dwordx2 v[138:139], v2, s[20:23], s49 offen offset:48
    s_barrier
    s_xor_b32 s101, s57, 2
    s_lshl_b32 s49, s101, 7
    s_add_u32 s49, s49, s52
    s_mul_i32 s100, s101, 229376
    s_add_u32 s49, s100, s55
    s_add_u32 m0, s59, 147456
    s_add_u32 s48, s49, 0
    buffer_load_dwordx4 v11, s[12:15], s48 offen lds
    s_add_u32 m0, s59, 148480
    s_add_u32 s48, s49, 28672
    buffer_load_dwordx4 v11, s[12:15], s48 offen lds
    s_add_u32 s49, s100, s56
    s_add_u32 m0, s59, 155648
    s_add_u32 s48, s49, 0
    buffer_load_dwordx4 v11, s[12:15], s48 offen lds
    s_add_u32 m0, s59, 156672
    s_add_u32 s48, s49, 28672
    buffer_load_dwordx4 v11, s[12:15], s48 offen lds
    s_waitcnt vmcnt(12)
    s_barrier
    s_waitcnt vmcnt(4)
    v_lshlrev_b32 v60, 16, v124
    v_and_b32 v61, 0xffff0000, v124
    v_lshlrev_b32 v62, 16, v125
    v_and_b32 v63, 0xffff0000, v125
    v_lshlrev_b32 v76, 16, v124
    v_and_b32 v77, 0xffff0000, v124
    v_lshlrev_b32 v78, 16, v125
    v_and_b32 v79, 0xffff0000, v125
    v_lshlrev_b32 v64, 16, v126
    v_and_b32 v65, 0xffff0000, v126
    v_lshlrev_b32 v66, 16, v127
    v_and_b32 v67, 0xffff0000, v127
    v_lshlrev_b32 v80, 16, v126
    v_and_b32 v81, 0xffff0000, v126
    v_lshlrev_b32 v82, 16, v127
    v_and_b32 v83, 0xffff0000, v127
    v_lshlrev_b32 v68, 16, v128
    v_and_b32 v69, 0xffff0000, v128
    v_lshlrev_b32 v70, 16, v129
    v_and_b32 v71, 0xffff0000, v129
    v_lshlrev_b32 v84, 16, v128
    v_and_b32 v85, 0xffff0000, v128
    v_lshlrev_b32 v86, 16, v129
    v_and_b32 v87, 0xffff0000, v129
    v_lshlrev_b32 v72, 16, v130
    v_and_b32 v73, 0xffff0000, v130
    v_lshlrev_b32 v74, 16, v131
    v_and_b32 v75, 0xffff0000, v131
    v_lshlrev_b32 v88, 16, v130
    v_and_b32 v89, 0xffff0000, v130
    v_lshlrev_b32 v90, 16, v131
    v_and_b32 v91, 0xffff0000, v131
    v_lshlrev_b32 v92, 16, v132
    v_and_b32 v93, 0xffff0000, v132
    v_lshlrev_b32 v94, 16, v133
    v_and_b32 v95, 0xffff0000, v133
    v_lshlrev_b32 v108, 16, v132
    v_and_b32 v109, 0xffff0000, v132
    v_lshlrev_b32 v110, 16, v133
    v_and_b32 v111, 0xffff0000, v133
    v_lshlrev_b32 v96, 16, v134
    v_and_b32 v97, 0xffff0000, v134
    v_lshlrev_b32 v98, 16, v135
    v_and_b32 v99, 0xffff0000, v135
    v_lshlrev_b32 v112, 16, v134
    v_and_b32 v113, 0xffff0000, v134
    v_lshlrev_b32 v114, 16, v135
    v_and_b32 v115, 0xffff0000, v135
    v_lshlrev_b32 v100, 16, v136
    v_and_b32 v101, 0xffff0000, v136
    v_lshlrev_b32 v102, 16, v137
    v_and_b32 v103, 0xffff0000, v137
    v_lshlrev_b32 v116, 16, v136
    v_and_b32 v117, 0xffff0000, v136
    v_lshlrev_b32 v118, 16, v137
    v_and_b32 v119, 0xffff0000, v137
    v_lshlrev_b32 v104, 16, v138
    v_and_b32 v105, 0xffff0000, v138
    v_lshlrev_b32 v106, 16, v139
    v_and_b32 v107, 0xffff0000, v139
    v_lshlrev_b32 v120, 16, v138
    v_and_b32 v121, 0xffff0000, v138
    v_lshlrev_b32 v122, 16, v139
    v_and_b32 v123, 0xffff0000, v139
    s_barrier
    s_waitcnt vmcnt(0)
    s_barrier
    s_branch L_pass2R
L_loadR1:
    s_waitcnt lgkmcnt(0)
    s_mov_b32 s4, s60
    s_and_b32 s5, s61, 0xffff
    s_mov_b32 s6, 0x200000
    s_mov_b32 s7, 0x00020000
    s_mov_b32 s8, s62
    s_and_b32 s9, s63, 0xffff
    s_mov_b32 s10, 0x180000
    s_mov_b32 s11, 0x00020000
    s_xor_b32 s101, s57, 1
    s_lshl_b32 s49, s101, 7
    s_add_u32 s49, s49, s52
    s_mul_i32 s100, s101, 196608
    s_add_u32 m0, s58, 16384
    s_add_u32 s48, s49, 0
    buffer_load_dwordx4 v8, s[4:7], s48 offen lds
    s_add_u32 m0, s58, 17408
    s_add_u32 s48, s49, 8192
    buffer_load_dwordx4 v9, s[4:7], s48 offen lds
    s_add_u32 m0, s58, 18432
    s_add_u32 s48, s49, 16384
    buffer_load_dwordx4 v8, s[4:7], s48 offen lds
    s_add_u32 m0, s58, 19456
    s_add_u32 s48, s49, 24576
    buffer_load_dwordx4 v9, s[4:7], s48 offen lds
    s_add_u32 s49, s100, s53
    s_add_u32 m0, s59, 131072
    s_add_u32 s48, s49, 2048
    buffer_load_dwordx4 v10, s[8:11], s48 offen lds
    s_add_u32 m0, s59, 132096
    s_add_u32 s48, s49, 26624
    buffer_load_dwordx4 v10, s[8:11], s48 offen lds
    s_mov_b32 s12, s68
    s_and_b32 s13, s69, 0xffff
    s_mov_b32 s14, 0x1c0000
    s_mov_b32 s15, 0x00020000
    s_mov_b32 s16, s80
    s_and_b32 s17, s81, 0xffff
    s_mov_b32 s18, 0x1800000
    s_mov_b32 s19, 0x00020000
    s_mov_b32 s24, s78
    s_and_b32 s25, s79, 0xffff
    s_mov_b32 s26, 0x100
    s_mov_b32 s27, 0x00020000
    s_barrier
    s_xor_b32 s101, s57, 3
    s_lshl_b32 s49, s101, 7
    s_add_u32 s49, s49, s52
    s_mul_i32 s100, s101, 196608
    s_add_u32 m0, s58, 49152
    s_add_u32 s48, s49, 0
    buffer_load_dwordx4 v8, s[4:7], s48 offen lds
    s_add_u32 m0, s58, 50176
    s_add_u32 s48, s49, 8192
    buffer_load_dwordx4 v9, s[4:7], s48 offen lds
    s_add_u32 m0, s58, 51200
    s_add_u32 s48, s49, 16384
    buffer_load_dwordx4 v8, s[4:7], s48 offen lds
    s_add_u32 m0, s58, 52224
    s_add_u32 s48, s49, 24576
    buffer_load_dwordx4 v9, s[4:7], s48 offen lds
    s_add_u32 s49, s100, s53
    s_add_u32 m0, s59, 98304
    s_add_u32 s48, s49, 2048
    buffer_load_dwordx4 v10, s[8:11], s48 offen lds
    s_add_u32 m0, s59, 99328
    s_add_u32 s48, s49, 26624
    buffer_load_dwordx4 v10, s[8:11], s48 offen lds
    s_waitcnt vmcnt(6)
    s_barrier
    s_barrier
    s_xor_b32 s101, s57, 5
    s_lshl_b32 s49, s101, 7
    s_add_u32 s49, s49, s52
    s_mul_i32 s100, s101, 196608
    s_add_u32 m0, s58, 16384
    s_add_u32 s48, s49, 0
    buffer_load_dwordx4 v8, s[4:7], s48 offen lds
    s_add_u32 m0, s58, 17408
    s_add_u32 s48, s49, 8192
    buffer_load_dwordx4 v9, s[4:7], s48 offen lds
    s_add_u32 m0, s58, 18432
    s_add_u32 s48, s49, 16384
    buffer_load_dwordx4 v8, s[4:7], s48 offen lds
    s_add_u32 m0, s58, 19456
    s_add_u32 s48, s49, 24576
    buffer_load_dwordx4 v9, s[4:7], s48 offen lds
    s_add_u32 s49, s100, s53
    s_add_u32 m0, s59, 131072
    s_add_u32 s48, s49, 2048
    buffer_load_dwordx4 v10, s[8:11], s48 offen lds
    s_add_u32 m0, s59, 132096
    s_add_u32 s48, s49, 26624
    buffer_load_dwordx4 v10, s[8:11], s48 offen lds
    s_waitcnt vmcnt(6)
    s_barrier
    s_barrier
    s_xor_b32 s101, s57, 7
    s_lshl_b32 s49, s101, 7
    s_add_u32 s49, s49, s52
    s_mul_i32 s100, s101, 196608
    s_add_u32 m0, s58, 81920
    s_add_u32 s48, s49, 0
    buffer_load_dwordx4 v8, s[4:7], s48 offen lds
    s_add_u32 m0, s58, 82944
    s_add_u32 s48, s49, 8192
    buffer_load_dwordx4 v9, s[4:7], s48 offen lds
    s_add_u32 m0, s58, 83968
    s_add_u32 s48, s49, 16384
    buffer_load_dwordx4 v8, s[4:7], s48 offen lds
    s_add_u32 m0, s58, 84992
    s_add_u32 s48, s49, 24576
    buffer_load_dwordx4 v9, s[4:7], s48 offen lds
    s_add_u32 s49, s100, s53
    s_add_u32 m0, s59, 98304
    s_add_u32 s48, s49, 2048
    buffer_load_dwordx4 v10, s[8:11], s48 offen lds
    s_add_u32 m0, s59, 99328
    s_add_u32 s48, s49, 26624
    buffer_load_dwordx4 v10, s[8:11], s48 offen lds
    s_waitcnt vmcnt(6)
    s_barrier
    s_barrier
    s_xor_b32 s101, s57, 3
    s_lshl_b32 s49, s101, 7
    s_add_u32 s49, s49, s52
    s_mul_i32 s100, s101, 229376
    s_add_u32 s49, s100, s55
    s_add_u32 m0, s59, 131072
    s_add_u32 s48, s49, 0
    buffer_load_dwordx4 v11, s[12:15], s48 offen lds
    s_add_u32 m0, s59, 132096
    s_add_u32 s48, s49, 28672
    buffer_load_dwordx4 v11, s[12:15], s48 offen lds
    s_add_u32 s49, s100, s56
    s_add_u32 m0, s59, 139264
    s_add_u32 s48, s49, 0
    buffer_load_dwordx4 v11, s[12:15], s48 offen lds
    s_add_u32 m0, s59, 140288
    s_add_u32 s48, s49, 28672
    buffer_load_dwordx4 v11, s[12:15], s48 offen lds
    s_waitcnt vmcnt(4)
    s_barrier
    s_xor_b32 s101, s57, 4
    s_lshl_b32 s49, s101, 7
    s_add_u32 s49, s49, s52
    s_mul_i32 s100, s101, 229376
    s_add_u32 s49, s100, s55
    s_add_u32 m0, s59, 114688
    s_add_u32 s48, s49, 0
    buffer_load_dwordx4 v11, s[12:15], s48 offen lds
    s_add_u32 m0, s59, 115712
    s_add_u32 s48, s49, 28672
    buffer_load_dwordx4 v11, s[12:15], s48 offen lds
    s_add_u32 s49, s100, s56
    s_add_u32 m0, s59, 122880
    s_add_u32 s48, s49, 0
    buffer_load_dwordx4 v11, s[12:15], s48 offen lds
    s_add_u32 m0, s59, 123904
    s_add_u32 s48, s49, 28672
    buffer_load_dwordx4 v11, s[12:15], s48 offen lds
    s_barrier
    s_xor_b32 s101, s57, 5
    s_lshl_b32 s49, s101, 7
    s_add_u32 s49, s49, s52
    s_mul_i32 s100, s101, 229376
    s_add_u32 s49, s100, s55
    s_add_u32 m0, s59, 98304
    s_add_u32 s48, s49, 0
    buffer_load_dwordx4 v11, s[12:15], s48 offen lds
    s_add_u32 m0, s59, 99328
    s_add_u32 s48, s49, 28672
    buffer_load_dwordx4 v11, s[12:15], s48 offen lds
    s_add_u32 s49, s100, s56
    s_add_u32 m0, s59, 106496
    s_add_u32 s48, s49, 0
    buffer_load_dwordx4 v11, s[12:15], s48 offen lds
    s_add_u32 m0, s59, 107520
    s_add_u32 s48, s49, 28672
    buffer_load_dwordx4 v11, s[12:15], s48 offen lds
    s_waitcnt vmcnt(8)
    s_barrier
    s_xor_b32 s101, s57, 6
    s_lshl_b32 s49, s101, 7
    s_add_u32 s49, s49, s52
    s_mul_i32 s100, s101, 229376
    s_add_u32 s49, s100, s55
    s_add_u32 m0, s59, 147456
    s_add_u32 s48, s49, 0
    buffer_load_dwordx4 v11, s[12:15], s48 offen lds
    s_add_u32 m0, s59, 148480
    s_add_u32 s48, s49, 28672
    buffer_load_dwordx4 v11, s[12:15], s48 offen lds
    s_add_u32 s49, s100, s56
    s_add_u32 m0, s59, 155648
    s_add_u32 s48, s49, 0
    buffer_load_dwordx4 v11, s[12:15], s48 offen lds
    s_add_u32 m0, s59, 156672
    s_add_u32 s48, s49, 28672
    buffer_load_dwordx4 v11, s[12:15], s48 offen lds
    s_waitcnt vmcnt(8)
    s_barrier
    s_xor_b32 s101, s57, 7
    s_lshl_b32 s49, s101, 7
    s_add_u32 s49, s49, s52
    s_mul_i32 s100, s101, 229376
    s_add_u32 s49, s100, s55
    s_add_u32 m0, s59, 131072
    s_add_u32 s48, s49, 0
    buffer_load_dwordx4 v11, s[12:15], s48 offen lds
    s_add_u32 m0, s59, 132096
    s_add_u32 s48, s49, 28672
    buffer_load_dwordx4 v11, s[12:15], s48 offen lds
    s_add_u32 s49, s100, s56
    s_add_u32 m0, s59, 139264
    s_add_u32 s48, s49, 0
    buffer_load_dwordx4 v11, s[12:15], s48 offen lds
    s_add_u32 m0, s59, 140288
    s_add_u32 s48, s49, 28672
    buffer_load_dwordx4 v11, s[12:15], s48 offen lds
    s_waitcnt vmcnt(8)
    s_barrier
    s_xor_b32 s101, s57, 0
    s_lshl_b32 s49, s101, 7
    s_add_u32 s49, s49, s52
    s_mul_i32 s100, s101, 229376
    s_add_u32 m0, s58, 0
    s_add_u32 s48, s49, 0
    buffer_load_dwordx4 v8, s[4:7], s48 offen lds
    s_add_u32 m0, s58, 1024
    s_add_u32 s48, s49, 8192
    buffer_load_dwordx4 v9, s[4:7], s48 offen lds
    s_add_u32 m0, s58, 2048
    s_add_u32 s48, s49, 16384
    buffer_load_dwordx4 v8, s[4:7], s48 offen lds
    s_add_u32 m0, s58, 3072
    s_add_u32 s48, s49, 24576
    buffer_load_dwordx4 v9, s[4:7], s48 offen lds
    s_add_u32 s49, s100, s55
    s_add_u32 m0, s59, 114688
    s_add_u32 s48, s49, 0
    buffer_load_dwordx4 v11, s[12:15], s48 offen lds
    s_add_u32 m0, s59, 115712
    s_add_u32 s48, s49, 28672
    buffer_load_dwordx4 v11, s[12:15], s48 offen lds
    s_add_u32 s49, s100, s56
    s_add_u32 m0, s59, 122880
    s_add_u32 s48, s49, 0
    buffer_load_dwordx4 v11, s[12:15], s48 offen lds
    s_add_u32 m0, s59, 123904
    s_add_u32 s48, s49, 28672
    buffer_load_dwordx4 v11, s[12:15], s48 offen lds
    s_waitcnt vmcnt(12)
    s_barrier
    s_xor_b32 s101, s57, 1
    s_lshl_b32 s49, s101, 7
    s_add_u32 s49, s49, s52
    s_mul_i32 s100, s101, 229376
    s_add_u32 m0, s58, 16384
    s_add_u32 s48, s49, 0
    buffer_load_dwordx4 v8, s[4:7], s48 offen lds
    s_add_u32 m0, s58, 17408
    s_add_u32 s48, s49, 8192
    buffer_load_dwordx4 v9, s[4:7], s48 offen lds
    s_add_u32 m0, s58, 18432
    s_add_u32 s48, s49, 16384
    buffer_load_dwordx4 v8, s[4:7], s48 offen lds
    s_add_u32 m0, s58, 19456
    s_add_u32 s48, s49, 24576
    buffer_load_dwordx4 v9, s[4:7], s48 offen lds
    s_add_u32 s49, s100, s55
    s_add_u32 m0, s59, 98304
    s_add_u32 s48, s49, 0
    buffer_load_dwordx4 v11, s[12:15], s48 offen lds
    s_add_u32 m0, s59, 99328
    s_add_u32 s48, s49, 28672
    buffer_load_dwordx4 v11, s[12:15], s48 offen lds
    s_add_u32 s49, s100, s56
    s_add_u32 m0, s59, 106496
    s_add_u32 s48, s49, 0
    buffer_load_dwordx4 v11, s[12:15], s48 offen lds
    s_add_u32 m0, s59, 107520
    s_add_u32 s48, s49, 28672
    buffer_load_dwordx4 v11, s[12:15], s48 offen lds
    s_waitcnt vmcnt(16)
    s_barrier
    s_waitcnt vmcnt(8)
    s_barrier
    s_waitcnt vmcnt(0)
    s_barrier
    s_barrier
    s_branch L_after_ab1
L_pass2P:
    ds_read_b128 v[124:127], v40
    ds_read_b64_tr_b16 v[132:133], v48 offset:0
    ds_read_b64_tr_b16 v[134:135], v48 offset:256
    ds_read_b128 v[128:131], v44
    ds_read_b64_tr_b16 v[136:137], v48 offset:8192
    ds_read_b64_tr_b16 v[138:139], v48 offset:8448
    ds_read_b128 v[140:143], v41
    ds_read_b64_tr_b16 v[148:149], v48 offset:2048
    ds_read_b64_tr_b16 v[150:151], v48 offset:2304
    ds_read_b128 v[144:147], v45
    ds_read_b64_tr_b16 v[152:153], v48 offset:10240
    ds_read_b64_tr_b16 v[154:155], v48 offset:10496
    s_mov_b32 s56, 8
    s_mov_b32 s58, 0x1054103
.p2align 3
L_loopP2:
    s_waitcnt lgkmcnt(6)
    v_mfma_f32_32x32x16_bf16 v[60:75], v[132:135], v[124:127], v[60:75]
    ds_read_b128 v[8:11], v42
    ds_read_b64_tr_b16 v[16:17], v48 offset:4096
    ds_read_b64_tr_b16 v[18:19], v48 offset:4352
    ds_read_b128 v[12:15], v46
    ds_read_b64_tr_b16 v[20:21], v48 offset:12288
    v_mfma_f32_32x32x16_bf16 v[76:91], v[132:135], v[128:131], v[76:91]
    ds_read_b64_tr_b16 v[22:23], v48 offset:12544
    s_add_u32 s56, s56, 1
    s_and_b32 s48, s58, 15
    s_lshl_b32 s48, s48, 14
    s_lshr_b32 s58, s58, 4
    v_mfma_f32_32x32x16_bf16 v[92:107], v[136:139], v[124:127], v[92:107]
    s_and_b32 s49, s56, 3
    s_sub_u32 s49, 9, s49
    s_lshl_b32 s49, s49, 14
    s_waitcnt lgkmcnt(6)
    v_mfma_f32_32x32x16_bf16 v[60:75], v[148:151], v[140:143], v[60:75]
    ds_read_b128 v[24:27], v43
    ds_read_b64_tr_b16 v[32:33], v48 offset:6144
    v_mfma_f32_32x32x16_bf16 v[76:91], v[148:151], v[144:147], v[76:91]
    ds_read_b64_tr_b16 v[34:35], v48 offset:6400
    ds_read_b128 v[28:31], v47
    v_mfma_f32_32x32x16_bf16 v[92:107], v[152:155], v[140:143], v[92:107]
    ds_read_b64_tr_b16 v[36:37], v48 offset:14336
    ds_read_b64_tr_b16 v[38:39], v48 offset:14592
    s_waitcnt lgkmcnt(6)
    v_mfma_f32_32x32x16_bf16 v[60:75], v[16:19], v[8:11], v[60:75]
    v_add_u32 v48, s49, v58
    v_add_u32 v40, s48, v50
    v_add_u32 v44, s48, v54
    v_add_u32 v41, s48, v51
    v_add_u32 v45, s48, v55
    v_mfma_f32_32x32x16_bf16 v[76:91], v[16:19], v[12:15], v[76:91]
    v_add_u32 v42, s48, v52
    v_add_u32 v46, s48, v56
    v_add_u32 v43, s48, v53
    v_add_u32 v47, s48, v57
    v_mfma_f32_32x32x16_bf16 v[92:107], v[20:23], v[8:11], v[92:107]
    s_waitcnt lgkmcnt(0)
    s_barrier
    ds_read_b128 v[124:127], v40
    ds_read_b64_tr_b16 v[132:133], v48 offset:0
    ds_read_b64_tr_b16 v[134:135], v48 offset:256
    ds_read_b128 v[128:131], v44
    ds_read_b64_tr_b16 v[136:137], v48 offset:8192
    ds_read_b64_tr_b16 v[138:139], v48 offset:8448
    v_mfma_f32_32x32x16_bf16 v[60:75], v[32:35], v[24:27], v[60:75]
    ds_read_b128 v[140:143], v41
    ds_read_b64_tr_b16 v[148:149], v48 offset:2048
    v_mfma_f32_32x32x16_bf16 v[76:91], v[32:35], v[28:31], v[76:91]
    ds_read_b64_tr_b16 v[150:151], v48 offset:2304
    ds_read_b128 v[144:147], v45
    v_mfma_f32_32x32x16_bf16 v[92:107], v[36:39], v[24:27], v[92:107]
    ds_read_b64_tr_b16 v[152:153], v48 offset:10240
    ds_read_b64_tr_b16 v[154:155], v48 offset:10496
    s_cmp_lt_u32 s56, 16
    s_cbranch_scc1 L_loopP2
    s_waitcnt lgkmcnt(0)
    s_mov_b32 s56, 0x3fb8aa3b
    s_mov_b32 s57, 0x3fb8aa3b
    s_mov_b32 s58, 2.0
    s_mov_b32 s59, 2.0
    s_mov_b32 s50, 0x41f00000
    s_and_b32 s48, s41, 3
    s_lshl_b32 s48, s48, 10
    s_add_u32 s48, s48, 32768
    v_add_u32 v2, s48, v1
    s_setprio 3
    s_nop 4
    v_pk_mul_f32 v[124:125], v[60:61], s[56:57]
    v_pk_mul_f32 v[126:127], v[62:63], s[56:57]
    v_pk_mul_f32 v[128:129], v[64:65], s[56:57]
    v_pk_mul_f32 v[130:131], v[66:67], s[56:57]
    v_min_f32 v124, s50, v124
    v_min_f32 v125, s50, v125
    v_min_f32 v126, s50, v126
    v_min_f32 v127, s50, v127
    v_min_f32 v128, s50, v128
    v_min_f32 v129, s50, v129
    v_min_f32 v130, s50, v130
    v_min_f32 v131, s50, v131
    v_exp_f32 v124, v124
    v_exp_f32 v125, v125
    v_exp_f32 v126, v126
    v_exp_f32 v127, v127
    v_exp_f32 v128, v128
    v_exp_f32 v129, v129
    v_exp_f32 v130, v130
    v_exp_f32 v131, v131
    v_pk_add_f32 v[132:133], v[124:125], s[58:59]
    v_pk_add_f32 v[134:135], v[126:127], s[58:59]
    v_pk_add_f32 v[136:137], v[128:129], s[58:59]
    v_pk_add_f32 v[138:139], v[130:131], s[58:59]
    v_pk_mul_f32 v[124:125], v[124:125], v[132:133]
    v_pk_mul_f32 v[126:127], v[126:127], v[134:135]
    v_pk_mul_f32 v[128:129], v[128:129], v[136:137]
    v_pk_mul_f32 v[130:131], v[130:131], v[138:139]
    v_pk_add_f32 v[132:133], v[124:125], s[58:59]
    v_pk_add_f32 v[134:135], v[126:127], s[58:59]
    v_pk_add_f32 v[136:137], v[128:129], s[58:59]
    v_pk_add_f32 v[138:139], v[130:131], s[58:59]
    v_rcp_f32 v132, v132
    v_rcp_f32 v133, v133
    v_rcp_f32 v134, v134
    v_rcp_f32 v135, v135
    v_rcp_f32 v136, v136
    v_rcp_f32 v137, v137
    v_rcp_f32 v138, v138
    v_rcp_f32 v139, v139
    v_pk_mul_f32 v[124:125], v[124:125], v[132:133]
    v_pk_mul_f32 v[126:127], v[126:127], v[134:135]
    v_pk_mul_f32 v[128:129], v[128:129], v[136:137]
    v_pk_mul_f32 v[130:131], v[130:131], v[138:139]
    v_pk_mul_f32 v[124:125], v[124:125], v[60:61]
    v_pk_mul_f32 v[126:127], v[126:127], v[62:63]
    v_pk_mul_f32 v[128:129], v[128:129], v[64:65]
    v_pk_mul_f32 v[130:131], v[130:131], v[66:67]
    v_cvt_pk_bf16_f32 v140, v124, v125
    v_cvt_pk_bf16_f32 v141, v126, v127
    v_cvt_pk_bf16_f32 v142, v128, v129
    v_cvt_pk_bf16_f32 v143, v130, v131
    v_pk_mul_f32 v[124:125], v[68:69], s[56:57]
    v_pk_mul_f32 v[126:127], v[70:71], s[56:57]
    v_pk_mul_f32 v[128:129], v[72:73], s[56:57]
    v_pk_mul_f32 v[130:131], v[74:75], s[56:57]
    v_min_f32 v124, s50, v124
    v_min_f32 v125, s50, v125
    v_min_f32 v126, s50, v126
    v_min_f32 v127, s50, v127
    v_min_f32 v128, s50, v128
    v_min_f32 v129, s50, v129
    v_min_f32 v130, s50, v130
    v_min_f32 v131, s50, v131
    v_exp_f32 v124, v124
    v_exp_f32 v125, v125
    v_exp_f32 v126, v126
    v_exp_f32 v127, v127
    v_exp_f32 v128, v128
    v_exp_f32 v129, v129
    v_exp_f32 v130, v130
    v_exp_f32 v131, v131
    v_pk_add_f32 v[132:133], v[124:125], s[58:59]
    v_pk_add_f32 v[134:135], v[126:127], s[58:59]
    v_pk_add_f32 v[136:137], v[128:129], s[58:59]
    v_pk_add_f32 v[138:139], v[130:131], s[58:59]
    v_pk_mul_f32 v[124:125], v[124:125], v[132:133]
    v_pk_mul_f32 v[126:127], v[126:127], v[134:135]
    v_pk_mul_f32 v[128:129], v[128:129], v[136:137]
    v_pk_mul_f32 v[130:131], v[130:131], v[138:139]
    v_pk_add_f32 v[132:133], v[124:125], s[58:59]
    v_pk_add_f32 v[134:135], v[126:127], s[58:59]
    v_pk_add_f32 v[136:137], v[128:129], s[58:59]
    v_pk_add_f32 v[138:139], v[130:131], s[58:59]
    v_rcp_f32 v132, v132
    v_rcp_f32 v133, v133
    v_rcp_f32 v134, v134
    v_rcp_f32 v135, v135
    v_rcp_f32 v136, v136
    v_rcp_f32 v137, v137
    v_rcp_f32 v138, v138
    v_rcp_f32 v139, v139
    v_pk_mul_f32 v[124:125], v[124:125], v[132:133]
    v_pk_mul_f32 v[126:127], v[126:127], v[134:135]
    v_pk_mul_f32 v[128:129], v[128:129], v[136:137]
    v_pk_mul_f32 v[130:131], v[130:131], v[138:139]
    v_pk_mul_f32 v[124:125], v[124:125], v[68:69]
    v_pk_mul_f32 v[126:127], v[126:127], v[70:71]
    v_pk_mul_f32 v[128:129], v[128:129], v[72:73]
    v_pk_mul_f32 v[130:131], v[130:131], v[74:75]
    v_cvt_pk_bf16_f32 v144, v124, v125
    v_cvt_pk_bf16_f32 v145, v126, v127
    v_cvt_pk_bf16_f32 v146, v128, v129
    v_cvt_pk_bf16_f32 v147, v130, v131
    ds_write_b128 v2, v[140:143] offset:0
    ds_write_b128 v2, v[144:147] offset:4096
    v_pk_mul_f32 v[124:125], v[76:77], s[56:57]
    v_pk_mul_f32 v[126:127], v[78:79], s[56:57]
    v_pk_mul_f32 v[128:129], v[80:81], s[56:57]
    v_pk_mul_f32 v[130:131], v[82:83], s[56:57]
    v_min_f32 v124, s50, v124
    v_min_f32 v125, s50, v125
    v_min_f32 v126, s50, v126
    v_min_f32 v127, s50, v127
    v_min_f32 v128, s50, v128
    v_min_f32 v129, s50, v129
    v_min_f32 v130, s50, v130
    v_min_f32 v131, s50, v131
    v_exp_f32 v124, v124
    v_exp_f32 v125, v125
    v_exp_f32 v126, v126
    v_exp_f32 v127, v127
    v_exp_f32 v128, v128
    v_exp_f32 v129, v129
    v_exp_f32 v130, v130
    v_exp_f32 v131, v131
    v_pk_add_f32 v[132:133], v[124:125], s[58:59]
    v_pk_add_f32 v[134:135], v[126:127], s[58:59]
    v_pk_add_f32 v[136:137], v[128:129], s[58:59]
    v_pk_add_f32 v[138:139], v[130:131], s[58:59]
    v_pk_mul_f32 v[124:125], v[124:125], v[132:133]
    v_pk_mul_f32 v[126:127], v[126:127], v[134:135]
    v_pk_mul_f32 v[128:129], v[128:129], v[136:137]
    v_pk_mul_f32 v[130:131], v[130:131], v[138:139]
    v_pk_add_f32 v[132:133], v[124:125], s[58:59]
    v_pk_add_f32 v[134:135], v[126:127], s[58:59]
    v_pk_add_f32 v[136:137], v[128:129], s[58:59]
    v_pk_add_f32 v[138:139], v[130:131], s[58:59]
    v_rcp_f32 v132, v132
    v_rcp_f32 v133, v133
    v_rcp_f32 v134, v134
    v_rcp_f32 v135, v135
    v_rcp_f32 v136, v136
    v_rcp_f32 v137, v137
    v_rcp_f32 v138, v138
    v_rcp_f32 v139, v139
    v_pk_mul_f32 v[124:125], v[124:125], v[132:133]
    v_pk_mul_f32 v[126:127], v[126:127], v[134:135]
    v_pk_mul_f32 v[128:129], v[128:129], v[136:137]
    v_pk_mul_f32 v[130:131], v[130:131], v[138:139]
    v_pk_mul_f32 v[124:125], v[124:125], v[76:77]
    v_pk_mul_f32 v[126:127], v[126:127], v[78:79]
    v_pk_mul_f32 v[128:129], v[128:129], v[80:81]
    v_pk_mul_f32 v[130:131], v[130:131], v[82:83]
    v_cvt_pk_bf16_f32 v148, v124, v125
    v_cvt_pk_bf16_f32 v149, v126, v127
    v_cvt_pk_bf16_f32 v150, v128, v129
    v_cvt_pk_bf16_f32 v151, v130, v131
    v_pk_mul_f32 v[124:125], v[84:85], s[56:57]
    v_pk_mul_f32 v[126:127], v[86:87], s[56:57]
    v_pk_mul_f32 v[128:129], v[88:89], s[56:57]
    v_pk_mul_f32 v[130:131], v[90:91], s[56:57]
    v_min_f32 v124, s50, v124
    v_min_f32 v125, s50, v125
    v_min_f32 v126, s50, v126
    v_min_f32 v127, s50, v127
    v_min_f32 v128, s50, v128
    v_min_f32 v129, s50, v129
    v_min_f32 v130, s50, v130
    v_min_f32 v131, s50, v131
    v_exp_f32 v124, v124
    v_exp_f32 v125, v125
    v_exp_f32 v126, v126
    v_exp_f32 v127, v127
    v_exp_f32 v128, v128
    v_exp_f32 v129, v129
    v_exp_f32 v130, v130
    v_exp_f32 v131, v131
    v_pk_add_f32 v[132:133], v[124:125], s[58:59]
    v_pk_add_f32 v[134:135], v[126:127], s[58:59]
    v_pk_add_f32 v[136:137], v[128:129], s[58:59]
    v_pk_add_f32 v[138:139], v[130:131], s[58:59]
    v_pk_mul_f32 v[124:125], v[124:125], v[132:133]
    v_pk_mul_f32 v[126:127], v[126:127], v[134:135]
    v_pk_mul_f32 v[128:129], v[128:129], v[136:137]
    v_pk_mul_f32 v[130:131], v[130:131], v[138:139]
    v_pk_add_f32 v[132:133], v[124:125], s[58:59]
    v_pk_add_f32 v[134:135], v[126:127], s[58:59]
    v_pk_add_f32 v[136:137], v[128:129], s[58:59]
    v_pk_add_f32 v[138:139], v[130:131], s[58:59]
    v_rcp_f32 v132, v132
    v_rcp_f32 v133, v133
    v_rcp_f32 v134, v134
    v_rcp_f32 v135, v135
    v_rcp_f32 v136, v136
    v_rcp_f32 v137, v137
    v_rcp_f32 v138, v138
    v_rcp_f32 v139, v139
    v_pk_mul_f32 v[124:125], v[124:125], v[132:133]
    v_pk_mul_f32 v[126:127], v[126:127], v[134:135]
    v_pk_mul_f32 v[128:129], v[128:129], v[136:137]
    v_pk_mul_f32 v[130:131], v[130:131], v[138:139]
    v_pk_mul_f32 v[124:125], v[124:125], v[84:85]
    v_pk_mul_f32 v[126:127], v[126:127], v[86:87]
    v_pk_mul_f32 v[128:129], v[128:129], v[88:89]
    v_pk_mul_f32 v[130:131], v[130:131], v[90:91]
    v_cvt_pk_bf16_f32 v152, v124, v125
    v_cvt_pk_bf16_f32 v153, v126, v127
    v_cvt_pk_bf16_f32 v154, v128, v129
    v_cvt_pk_bf16_f32 v155, v130, v131
    ds_write_b128 v2, v[148:151] offset:8192
    ds_write_b128 v2, v[152:155] offset:12288
    v_pk_mul_f32 v[124:125], v[92:93], s[56:57]
    v_pk_mul_f32 v[126:127], v[94:95], s[56:57]
    v_pk_mul_f32 v[128:129], v[96:97], s[56:57]
    v_pk_mul_f32 v[130:131], v[98:99], s[56:57]
    v_min_f32 v124, s50, v124
    v_min_f32 v125, s50, v125
    v_min_f32 v126, s50, v126
    v_min_f32 v127, s50, v127
    v_min_f32 v128, s50, v128
    v_min_f32 v129, s50, v129
    v_min_f32 v130, s50, v130
    v_min_f32 v131, s50, v131
    v_exp_f32 v124, v124
    v_exp_f32 v125, v125
    v_exp_f32 v126, v126
    v_exp_f32 v127, v127
    v_exp_f32 v128, v128
    v_exp_f32 v129, v129
    v_exp_f32 v130, v130
    v_exp_f32 v131, v131
    v_pk_add_f32 v[132:133], v[124:125], s[58:59]
    v_pk_add_f32 v[134:135], v[126:127], s[58:59]
    v_pk_add_f32 v[136:137], v[128:129], s[58:59]
    v_pk_add_f32 v[138:139], v[130:131], s[58:59]
    v_pk_mul_f32 v[124:125], v[124:125], v[132:133]
    v_pk_mul_f32 v[126:127], v[126:127], v[134:135]
    v_pk_mul_f32 v[128:129], v[128:129], v[136:137]
    v_pk_mul_f32 v[130:131], v[130:131], v[138:139]
    v_pk_add_f32 v[132:133], v[124:125], s[58:59]
    v_pk_add_f32 v[134:135], v[126:127], s[58:59]
    v_pk_add_f32 v[136:137], v[128:129], s[58:59]
    v_pk_add_f32 v[138:139], v[130:131], s[58:59]
    v_rcp_f32 v132, v132
    v_rcp_f32 v133, v133
    v_rcp_f32 v134, v134
    v_rcp_f32 v135, v135
    v_rcp_f32 v136, v136
    v_rcp_f32 v137, v137
    v_rcp_f32 v138, v138
    v_rcp_f32 v139, v139
    v_pk_mul_f32 v[124:125], v[124:125], v[132:133]
    v_pk_mul_f32 v[126:127], v[126:127], v[134:135]
    v_pk_mul_f32 v[128:129], v[128:129], v[136:137]
    v_pk_mul_f32 v[130:131], v[130:131], v[138:139]
    v_pk_mul_f32 v[124:125], v[124:125], v[92:93]
    v_pk_mul_f32 v[126:127], v[126:127], v[94:95]
    v_pk_mul_f32 v[128:129], v[128:129], v[96:97]
    v_pk_mul_f32 v[130:131], v[130:131], v[98:99]
    v_cvt_pk_bf16_f32 v140, v124, v125
    v_cvt_pk_bf16_f32 v141, v126, v127
    v_cvt_pk_bf16_f32 v142, v128, v129
    v_cvt_pk_bf16_f32 v143, v130, v131
    v_pk_mul_f32 v[124:125], v[100:101], s[56:57]
    v_pk_mul_f32 v[126:127], v[102:103], s[56:57]
    v_pk_mul_f32 v[128:129], v[104:105], s[56:57]
    v_pk_mul_f32 v[130:131], v[106:107], s[56:57]
    v_min_f32 v124, s50, v124
    v_min_f32 v125, s50, v125
    v_min_f32 v126, s50, v126
    v_min_f32 v127, s50, v127
    v_min_f32 v128, s50, v128
    v_min_f32 v129, s50, v129
    v_min_f32 v130, s50, v130
    v_min_f32 v131, s50, v131
    v_exp_f32 v124, v124
    v_exp_f32 v125, v125
    v_exp_f32 v126, v126
    v_exp_f32 v127, v127
    v_exp_f32 v128, v128
    v_exp_f32 v129, v129
    v_exp_f32 v130, v130
    v_exp_f32 v131, v131
    v_pk_add_f32 v[132:133], v[124:125], s[58:59]
    v_pk_add_f32 v[134:135], v[126:127], s[58:59]
    v_pk_add_f32 v[136:137], v[128:129], s[58:59]
    v_pk_add_f32 v[138:139], v[130:131], s[58:59]
    v_pk_mul_f32 v[124:125], v[124:125], v[132:133]
    v_pk_mul_f32 v[126:127], v[126:127], v[134:135]
    v_pk_mul_f32 v[128:129], v[128:129], v[136:137]
    v_pk_mul_f32 v[130:131], v[130:131], v[138:139]
    v_pk_add_f32 v[132:133], v[124:125], s[58:59]
    v_pk_add_f32 v[134:135], v[126:127], s[58:59]
    v_pk_add_f32 v[136:137], v[128:129], s[58:59]
    v_pk_add_f32 v[138:139], v[130:131], s[58:59]
    v_rcp_f32 v132, v132
    v_rcp_f32 v133, v133
    v_rcp_f32 v134, v134
    v_rcp_f32 v135, v135
    v_rcp_f32 v136, v136
    v_rcp_f32 v137, v137
    v_rcp_f32 v138, v138
    v_rcp_f32 v139, v139
    v_pk_mul_f32 v[124:125], v[124:125], v[132:133]
    v_pk_mul_f32 v[126:127], v[126:127], v[134:135]
    v_pk_mul_f32 v[128:129], v[128:129], v[136:137]
    v_pk_mul_f32 v[130:131], v[130:131], v[138:139]
    v_pk_mul_f32 v[124:125], v[124:125], v[100:101]
    v_pk_mul_f32 v[126:127], v[126:127], v[102:103]
    v_pk_mul_f32 v[128:129], v[128:129], v[104:105]
    v_pk_mul_f32 v[130:131], v[130:131], v[106:107]
    v_cvt_pk_bf16_f32 v144, v124, v125
    v_cvt_pk_bf16_f32 v145, v126, v127
    v_cvt_pk_bf16_f32 v146, v128, v129
    v_cvt_pk_bf16_f32 v147, v130, v131
    ds_write_b128 v2, v[140:143] offset:16384
    ds_write_b128 v2, v[144:147] offset:20480
    s_mov_b64 exec, 1
    v_mov_b32 v4, 163796
    v_mov_b32 v5, 1
    ds_add_u32 v4, v5
    s_mov_b64 exec, -1
    s_branch L_attn_c
L_pass2R:
    ds_read_b128 v[124:127], v40
    ds_read_b64_tr_b16 v[132:133], v48 offset:0
    ds_read_b64_tr_b16 v[134:135], v48 offset:256
    ds_read_b128 v[128:131], v44
    ds_read_b64_tr_b16 v[136:137], v48 offset:8192
    ds_read_b64_tr_b16 v[138:139], v48 offset:8448
    ds_read_b128 v[140:143], v41
    ds_read_b64_tr_b16 v[148:149], v48 offset:2048
    ds_read_b64_tr_b16 v[150:151], v48 offset:2304
    ds_read_b128 v[144:147], v45
    ds_read_b64_tr_b16 v[152:153], v48 offset:10240
    ds_read_b64_tr_b16 v[154:155], v48 offset:10496
    s_mov_b32 s56, 8
    s_mov_b32 s58, 0x1054103
.p2align 3
L_loopR2:
    s_waitcnt lgkmcnt(6)
    v_mfma_f32_32x32x16_bf16 v[60:75], v[132:135], v[124:127], v[60:75]
    ds_read_b128 v[8:11], v42
    ds_read_b64_tr_b16 v[16:17], v48 offset:4096
    ds_read_b64_tr_b16 v[18:19], v48 offset:4352
    ds_read_b128 v[12:15], v46
    v_mfma_f32_32x32x16_bf16 v[76:91], v[132:135], v[128:131], v[76:91]
    ds_read_b64_tr_b16 v[20:21], v48 offset:12288
    ds_read_b64_tr_b16 v[22:23], v48 offset:12544
    s_add_u32 s56, s56, 1
    s_and_b32 s48, s58, 15
    v_mfma_f32_32x32x16_bf16 v[92:107], v[136:139], v[124:127], v[92:107]
    s_lshl_b32 s48, s48, 14
    s_lshr_b32 s58, s58, 4
    s_and_b32 s49, s56, 3
    s_sub_u32 s49, 9, s49
    v_mfma_f32_32x32x16_bf16 v[108:123], v[136:139], v[128:131], v[108:123]
    s_lshl_b32 s49, s49, 14
    s_waitcnt lgkmcnt(6)
    v_mfma_f32_32x32x16_bf16 v[60:75], v[148:151], v[140:143], v[60:75]
    ds_read_b128 v[24:27], v43
    ds_read_b64_tr_b16 v[32:33], v48 offset:6144
    v_mfma_f32_32x32x16_bf16 v[76:91], v[148:151], v[144:147], v[76:91]
    ds_read_b64_tr_b16 v[34:35], v48 offset:6400
    ds_read_b128 v[28:31], v47
    v_mfma_f32_32x32x16_bf16 v[92:107], v[152:155], v[140:143], v[92:107]
    ds_read_b64_tr_b16 v[36:37], v48 offset:14336
    ds_read_b64_tr_b16 v[38:39], v48 offset:14592
    v_mfma_f32_32x32x16_bf16 v[108:123], v[152:155], v[144:147], v[108:123]
    s_waitcnt lgkmcnt(6)
    v_mfma_f32_32x32x16_bf16 v[60:75], v[16:19], v[8:11], v[60:75]
    v_add_u32 v48, s49, v58
    v_add_u32 v40, s48, v50
    v_add_u32 v44, s48, v54
    v_mfma_f32_32x32x16_bf16 v[76:91], v[16:19], v[12:15], v[76:91]
    v_add_u32 v41, s48, v51
    v_add_u32 v45, s48, v55
    v_add_u32 v42, s48, v52
    v_mfma_f32_32x32x16_bf16 v[92:107], v[20:23], v[8:11], v[92:107]
    v_add_u32 v46, s48, v56
    v_add_u32 v43, s48, v53
    v_add_u32 v47, s48, v57
    v_mfma_f32_32x32x16_bf16 v[108:123], v[20:23], v[12:15], v[108:123]
    s_waitcnt lgkmcnt(0)
    s_barrier
    ds_read_b128 v[124:127], v40
    ds_read_b64_tr_b16 v[132:133], v48 offset:0
    ds_read_b64_tr_b16 v[134:135], v48 offset:256
    ds_read_b128 v[128:131], v44
    ds_read_b64_tr_b16 v[136:137], v48 offset:8192
    ds_read_b64_tr_b16 v[138:139], v48 offset:8448
    v_mfma_f32_32x32x16_bf16 v[60:75], v[32:35], v[24:27], v[60:75]
    ds_read_b128 v[140:143], v41
    ds_read_b64_tr_b16 v[148:149], v48 offset:2048
    v_mfma_f32_32x32x16_bf16 v[76:91], v[32:35], v[28:31], v[76:91]
    ds_read_b64_tr_b16 v[150:151], v48 offset:2304
    ds_read_b128 v[144:147], v45
    v_mfma_f32_32x32x16_bf16 v[92:107], v[36:39], v[24:27], v[92:107]
    ds_read_b64_tr_b16 v[152:153], v48 offset:10240
    ds_read_b64_tr_b16 v[154:155], v48 offset:10496
    v_mfma_f32_32x32x16_bf16 v[108:123], v[36:39], v[28:31], v[108:123]
    s_cmp_lt_u32 s56, 16
    s_cbranch_scc1 L_loopR2
    s_waitcnt lgkmcnt(0)
    s_mov_b32 s56, 0x3fb8aa3b
    s_mov_b32 s57, 0x3fb8aa3b
    s_mov_b32 s58, 2.0
    s_mov_b32 s59, 2.0
    s_mov_b32 s50, 0x41f00000
    s_and_b32 s48, s41, 3
    s_lshl_b32 s48, s48, 10
    s_add_u32 s48, s48, 32768
    v_add_u32 v2, s48, v1
    s_setprio 3
    s_nop 4
    v_pk_mul_f32 v[124:125], v[60:61], s[56:57]
    v_pk_mul_f32 v[126:127], v[62:63], s[56:57]
    v_pk_mul_f32 v[128:129], v[64:65], s[56:57]
    v_pk_mul_f32 v[130:131], v[66:67], s[56:57]
    v_min_f32 v124, s50, v124
    v_min_f32 v125, s50, v125
    v_min_f32 v126, s50, v126
    v_min_f32 v127, s50, v127
    v_min_f32 v128, s50, v128
    v_min_f32 v129, s50, v129
    v_min_f32 v130, s50, v130
    v_min_f32 v131, s50, v131
    v_exp_f32 v124, v124
    v_exp_f32 v125, v125
    v_exp_f32 v126, v126
    v_exp_f32 v127, v127
    v_exp_f32 v128, v128
    v_exp_f32 v129, v129
    v_exp_f32 v130, v130
    v_exp_f32 v131, v131
    v_pk_add_f32 v[132:133], v[124:125], s[58:59]
    v_pk_add_f32 v[134:135], v[126:127], s[58:59]
    v_pk_add_f32 v[136:137], v[128:129], s[58:59]
    v_pk_add_f32 v[138:139], v[130:131], s[58:59]
    v_pk_mul_f32 v[124:125], v[124:125], v[132:133]
    v_pk_mul_f32 v[126:127], v[126:127], v[134:135]
    v_pk_mul_f32 v[128:129], v[128:129], v[136:137]
    v_pk_mul_f32 v[130:131], v[130:131], v[138:139]
    v_pk_add_f32 v[132:133], v[124:125], s[58:59]
    v_pk_add_f32 v[134:135], v[126:127], s[58:59]
    v_pk_add_f32 v[136:137], v[128:129], s[58:59]
    v_pk_add_f32 v[138:139], v[130:131], s[58:59]
    v_rcp_f32 v132, v132
    v_rcp_f32 v133, v133
    v_rcp_f32 v134, v134
    v_rcp_f32 v135, v135
    v_rcp_f32 v136, v136
    v_rcp_f32 v137, v137
    v_rcp_f32 v138, v138
    v_rcp_f32 v139, v139
    v_pk_mul_f32 v[124:125], v[124:125], v[132:133]
    v_pk_mul_f32 v[126:127], v[126:127], v[134:135]
    v_pk_mul_f32 v[128:129], v[128:129], v[136:137]
    v_pk_mul_f32 v[130:131], v[130:131], v[138:139]
    v_pk_mul_f32 v[124:125], v[124:125], v[60:61]
    v_pk_mul_f32 v[126:127], v[126:127], v[62:63]
    v_pk_mul_f32 v[128:129], v[128:129], v[64:65]
    v_pk_mul_f32 v[130:131], v[130:131], v[66:67]
    v_cvt_pk_bf16_f32 v140, v124, v125
    v_cvt_pk_bf16_f32 v141, v126, v127
    v_cvt_pk_bf16_f32 v142, v128, v129
    v_cvt_pk_bf16_f32 v143, v130, v131
    v_pk_mul_f32 v[124:125], v[68:69], s[56:57]
    v_pk_mul_f32 v[126:127], v[70:71], s[56:57]
    v_pk_mul_f32 v[128:129], v[72:73], s[56:57]
    v_pk_mul_f32 v[130:131], v[74:75], s[56:57]
    v_min_f32 v124, s50, v124
    v_min_f32 v125, s50, v125
    v_min_f32 v126, s50, v126
    v_min_f32 v127, s50, v127
    v_min_f32 v128, s50, v128
    v_min_f32 v129, s50, v129
    v_min_f32 v130, s50, v130
    v_min_f32 v131, s50, v131
    v_exp_f32 v124, v124
    v_exp_f32 v125, v125
    v_exp_f32 v126, v126
    v_exp_f32 v127, v127
    v_exp_f32 v128, v128
    v_exp_f32 v129, v129
    v_exp_f32 v130, v130
    v_exp_f32 v131, v131
    v_pk_add_f32 v[132:133], v[124:125], s[58:59]
    v_pk_add_f32 v[134:135], v[126:127], s[58:59]
    v_pk_add_f32 v[136:137], v[128:129], s[58:59]
    v_pk_add_f32 v[138:139], v[130:131], s[58:59]
    v_pk_mul_f32 v[124:125], v[124:125], v[132:133]
    v_pk_mul_f32 v[126:127], v[126:127], v[134:135]
    v_pk_mul_f32 v[128:129], v[128:129], v[136:137]
    v_pk_mul_f32 v[130:131], v[130:131], v[138:139]
    v_pk_add_f32 v[132:133], v[124:125], s[58:59]
    v_pk_add_f32 v[134:135], v[126:127], s[58:59]
    v_pk_add_f32 v[136:137], v[128:129], s[58:59]
    v_pk_add_f32 v[138:139], v[130:131], s[58:59]
    v_rcp_f32 v132, v132
    v_rcp_f32 v133, v133
    v_rcp_f32 v134, v134
    v_rcp_f32 v135, v135
    v_rcp_f32 v136, v136
    v_rcp_f32 v137, v137
    v_rcp_f32 v138, v138
    v_rcp_f32 v139, v139
    v_pk_mul_f32 v[124:125], v[124:125], v[132:133]
    v_pk_mul_f32 v[126:127], v[126:127], v[134:135]
    v_pk_mul_f32 v[128:129], v[128:129], v[136:137]
    v_pk_mul_f32 v[130:131], v[130:131], v[138:139]
    v_pk_mul_f32 v[124:125], v[124:125], v[68:69]
    v_pk_mul_f32 v[126:127], v[126:127], v[70:71]
    v_pk_mul_f32 v[128:129], v[128:129], v[72:73]
    v_pk_mul_f32 v[130:131], v[130:131], v[74:75]
    v_cvt_pk_bf16_f32 v144, v124, v125
    v_cvt_pk_bf16_f32 v145, v126, v127
    v_cvt_pk_bf16_f32 v146, v128, v129
    v_cvt_pk_bf16_f32 v147, v130, v131
    ds_write_b128 v2, v[140:143] offset:0
    ds_write_b128 v2, v[144:147] offset:4096
    v_pk_mul_f32 v[124:125], v[76:77], s[56:57]
    v_pk_mul_f32 v[126:127], v[78:79], s[56:57]
    v_pk_mul_f32 v[128:129], v[80:81], s[56:57]
    v_pk_mul_f32 v[130:131], v[82:83], s[56:57]
    v_min_f32 v124, s50, v124
    v_min_f32 v125, s50, v125
    v_min_f32 v126, s50, v126
    v_min_f32 v127, s50, v127
    v_min_f32 v128, s50, v128
    v_min_f32 v129, s50, v129
    v_min_f32 v130, s50, v130
    v_min_f32 v131, s50, v131
    v_exp_f32 v124, v124
    v_exp_f32 v125, v125
    v_exp_f32 v126, v126
    v_exp_f32 v127, v127
    v_exp_f32 v128, v128
    v_exp_f32 v129, v129
    v_exp_f32 v130, v130
    v_exp_f32 v131, v131
    v_pk_add_f32 v[132:133], v[124:125], s[58:59]
    v_pk_add_f32 v[134:135], v[126:127], s[58:59]
    v_pk_add_f32 v[136:137], v[128:129], s[58:59]
    v_pk_add_f32 v[138:139], v[130:131], s[58:59]
    v_pk_mul_f32 v[124:125], v[124:125], v[132:133]
    v_pk_mul_f32 v[126:127], v[126:127], v[134:135]
    v_pk_mul_f32 v[128:129], v[128:129], v[136:137]
    v_pk_mul_f32 v[130:131], v[130:131], v[138:139]
    v_pk_add_f32 v[132:133], v[124:125], s[58:59]
    v_pk_add_f32 v[134:135], v[126:127], s[58:59]
    v_pk_add_f32 v[136:137], v[128:129], s[58:59]
    v_pk_add_f32 v[138:139], v[130:131], s[58:59]
    v_rcp_f32 v132, v132
    v_rcp_f32 v133, v133
    v_rcp_f32 v134, v134
    v_rcp_f32 v135, v135
    v_rcp_f32 v136, v136
    v_rcp_f32 v137, v137
    v_rcp_f32 v138, v138
    v_rcp_f32 v139, v139
    v_pk_mul_f32 v[124:125], v[124:125], v[132:133]
    v_pk_mul_f32 v[126:127], v[126:127], v[134:135]
    v_pk_mul_f32 v[128:129], v[128:129], v[136:137]
    v_pk_mul_f32 v[130:131], v[130:131], v[138:139]
    v_pk_mul_f32 v[124:125], v[124:125], v[76:77]
    v_pk_mul_f32 v[126:127], v[126:127], v[78:79]
    v_pk_mul_f32 v[128:129], v[128:129], v[80:81]
    v_pk_mul_f32 v[130:131], v[130:131], v[82:83]
    v_cvt_pk_bf16_f32 v148, v124, v125
    v_cvt_pk_bf16_f32 v149, v126, v127
    v_cvt_pk_bf16_f32 v150, v128, v129
    v_cvt_pk_bf16_f32 v151, v130, v131
    v_pk_mul_f32 v[124:125], v[84:85], s[56:57]
    v_pk_mul_f32 v[126:127], v[86:87], s[56:57]
    v_pk_mul_f32 v[128:129], v[88:89], s[56:57]
    v_pk_mul_f32 v[130:131], v[90:91], s[56:57]
    v_min_f32 v124, s50, v124
    v_min_f32 v125, s50, v125
    v_min_f32 v126, s50, v126
    v_min_f32 v127, s50, v127
    v_min_f32 v128, s50, v128
    v_min_f32 v129, s50, v129
    v_min_f32 v130, s50, v130
    v_min_f32 v131, s50, v131
    v_exp_f32 v124, v124
    v_exp_f32 v125, v125
    v_exp_f32 v126, v126
    v_exp_f32 v127, v127
    v_exp_f32 v128, v128
    v_exp_f32 v129, v129
    v_exp_f32 v130, v130
    v_exp_f32 v131, v131
    v_pk_add_f32 v[132:133], v[124:125], s[58:59]
    v_pk_add_f32 v[134:135], v[126:127], s[58:59]
    v_pk_add_f32 v[136:137], v[128:129], s[58:59]
    v_pk_add_f32 v[138:139], v[130:131], s[58:59]
    v_pk_mul_f32 v[124:125], v[124:125], v[132:133]
    v_pk_mul_f32 v[126:127], v[126:127], v[134:135]
    v_pk_mul_f32 v[128:129], v[128:129], v[136:137]
    v_pk_mul_f32 v[130:131], v[130:131], v[138:139]
    v_pk_add_f32 v[132:133], v[124:125], s[58:59]
    v_pk_add_f32 v[134:135], v[126:127], s[58:59]
    v_pk_add_f32 v[136:137], v[128:129], s[58:59]
    v_pk_add_f32 v[138:139], v[130:131], s[58:59]
    v_rcp_f32 v132, v132
    v_rcp_f32 v133, v133
    v_rcp_f32 v134, v134
    v_rcp_f32 v135, v135
    v_rcp_f32 v136, v136
    v_rcp_f32 v137, v137
    v_rcp_f32 v138, v138
    v_rcp_f32 v139, v139
    v_pk_mul_f32 v[124:125], v[124:125], v[132:133]
    v_pk_mul_f32 v[126:127], v[126:127], v[134:135]
    v_pk_mul_f32 v[128:129], v[128:129], v[136:137]
    v_pk_mul_f32 v[130:131], v[130:131], v[138:139]
    v_pk_mul_f32 v[124:125], v[124:125], v[84:85]
    v_pk_mul_f32 v[126:127], v[126:127], v[86:87]
    v_pk_mul_f32 v[128:129], v[128:129], v[88:89]
    v_pk_mul_f32 v[130:131], v[130:131], v[90:91]
    v_cvt_pk_bf16_f32 v152, v124, v125
    v_cvt_pk_bf16_f32 v153, v126, v127
    v_cvt_pk_bf16_f32 v154, v128, v129
    v_cvt_pk_bf16_f32 v155, v130, v131
    ds_write_b128 v2, v[148:151] offset:8192
    ds_write_b128 v2, v[152:155] offset:12288
    v_pk_mul_f32 v[124:125], v[92:93], s[56:57]
    v_pk_mul_f32 v[126:127], v[94:95], s[56:57]
    v_pk_mul_f32 v[128:129], v[96:97], s[56:57]
    v_pk_mul_f32 v[130:131], v[98:99], s[56:57]
    v_min_f32 v124, s50, v124
    v_min_f32 v125, s50, v125
    v_min_f32 v126, s50, v126
    v_min_f32 v127, s50, v127
    v_min_f32 v128, s50, v128
    v_min_f32 v129, s50, v129
    v_min_f32 v130, s50, v130
    v_min_f32 v131, s50, v131
    v_exp_f32 v124, v124
    v_exp_f32 v125, v125
    v_exp_f32 v126, v126
    v_exp_f32 v127, v127
    v_exp_f32 v128, v128
    v_exp_f32 v129, v129
    v_exp_f32 v130, v130
    v_exp_f32 v131, v131
    v_pk_add_f32 v[132:133], v[124:125], s[58:59]
    v_pk_add_f32 v[134:135], v[126:127], s[58:59]
    v_pk_add_f32 v[136:137], v[128:129], s[58:59]
    v_pk_add_f32 v[138:139], v[130:131], s[58:59]
    v_pk_mul_f32 v[124:125], v[124:125], v[132:133]
    v_pk_mul_f32 v[126:127], v[126:127], v[134:135]
    v_pk_mul_f32 v[128:129], v[128:129], v[136:137]
    v_pk_mul_f32 v[130:131], v[130:131], v[138:139]
    v_pk_add_f32 v[132:133], v[124:125], s[58:59]
    v_pk_add_f32 v[134:135], v[126:127], s[58:59]
    v_pk_add_f32 v[136:137], v[128:129], s[58:59]
    v_pk_add_f32 v[138:139], v[130:131], s[58:59]
    v_rcp_f32 v132, v132
    v_rcp_f32 v133, v133
    v_rcp_f32 v134, v134
    v_rcp_f32 v135, v135
    v_rcp_f32 v136, v136
    v_rcp_f32 v137, v137
    v_rcp_f32 v138, v138
    v_rcp_f32 v139, v139
    v_pk_mul_f32 v[124:125], v[124:125], v[132:133]
    v_pk_mul_f32 v[126:127], v[126:127], v[134:135]
    v_pk_mul_f32 v[128:129], v[128:129], v[136:137]
    v_pk_mul_f32 v[130:131], v[130:131], v[138:139]
    v_pk_mul_f32 v[124:125], v[124:125], v[92:93]
    v_pk_mul_f32 v[126:127], v[126:127], v[94:95]
    v_pk_mul_f32 v[128:129], v[128:129], v[96:97]
    v_pk_mul_f32 v[130:131], v[130:131], v[98:99]
    v_cvt_pk_bf16_f32 v140, v124, v125
    v_cvt_pk_bf16_f32 v141, v126, v127
    v_cvt_pk_bf16_f32 v142, v128, v129
    v_cvt_pk_bf16_f32 v143, v130, v131
    v_pk_mul_f32 v[124:125], v[100:101], s[56:57]
    v_pk_mul_f32 v[126:127], v[102:103], s[56:57]
    v_pk_mul_f32 v[128:129], v[104:105], s[56:57]
    v_pk_mul_f32 v[130:131], v[106:107], s[56:57]
    v_min_f32 v124, s50, v124
    v_min_f32 v125, s50, v125
    v_min_f32 v126, s50, v126
    v_min_f32 v127, s50, v127
    v_min_f32 v128, s50, v128
    v_min_f32 v129, s50, v129
    v_min_f32 v130, s50, v130
    v_min_f32 v131, s50, v131
    v_exp_f32 v124, v124
    v_exp_f32 v125, v125
    v_exp_f32 v126, v126
    v_exp_f32 v127, v127
    v_exp_f32 v128, v128
    v_exp_f32 v129, v129
    v_exp_f32 v130, v130
    v_exp_f32 v131, v131
    v_pk_add_f32 v[132:133], v[124:125], s[58:59]
    v_pk_add_f32 v[134:135], v[126:127], s[58:59]
    v_pk_add_f32 v[136:137], v[128:129], s[58:59]
    v_pk_add_f32 v[138:139], v[130:131], s[58:59]
    v_pk_mul_f32 v[124:125], v[124:125], v[132:133]
    v_pk_mul_f32 v[126:127], v[126:127], v[134:135]
    v_pk_mul_f32 v[128:129], v[128:129], v[136:137]
    v_pk_mul_f32 v[130:131], v[130:131], v[138:139]
    v_pk_add_f32 v[132:133], v[124:125], s[58:59]
    v_pk_add_f32 v[134:135], v[126:127], s[58:59]
    v_pk_add_f32 v[136:137], v[128:129], s[58:59]
    v_pk_add_f32 v[138:139], v[130:131], s[58:59]
    v_rcp_f32 v132, v132
    v_rcp_f32 v133, v133
    v_rcp_f32 v134, v134
    v_rcp_f32 v135, v135
    v_rcp_f32 v136, v136
    v_rcp_f32 v137, v137
    v_rcp_f32 v138, v138
    v_rcp_f32 v139, v139
    v_pk_mul_f32 v[124:125], v[124:125], v[132:133]
    v_pk_mul_f32 v[126:127], v[126:127], v[134:135]
    v_pk_mul_f32 v[128:129], v[128:129], v[136:137]
    v_pk_mul_f32 v[130:131], v[130:131], v[138:139]
    v_pk_mul_f32 v[124:125], v[124:125], v[100:101]
    v_pk_mul_f32 v[126:127], v[126:127], v[102:103]
    v_pk_mul_f32 v[128:129], v[128:129], v[104:105]
    v_pk_mul_f32 v[130:131], v[130:131], v[106:107]
    v_cvt_pk_bf16_f32 v144, v124, v125
    v_cvt_pk_bf16_f32 v145, v126, v127
    v_cvt_pk_bf16_f32 v146, v128, v129
    v_cvt_pk_bf16_f32 v147, v130, v131
    ds_write_b128 v2, v[140:143] offset:16384
    ds_write_b128 v2, v[144:147] offset:20480
    v_pk_mul_f32 v[124:125], v[108:109], s[56:57]
    v_pk_mul_f32 v[126:127], v[110:111], s[56:57]
    v_pk_mul_f32 v[128:129], v[112:113], s[56:57]
    v_pk_mul_f32 v[130:131], v[114:115], s[56:57]
    v_min_f32 v124, s50, v124
    v_min_f32 v125, s50, v125
    v_min_f32 v126, s50, v126
    v_min_f32 v127, s50, v127
    v_min_f32 v128, s50, v128
    v_min_f32 v129, s50, v129
    v_min_f32 v130, s50, v130
    v_min_f32 v131, s50, v131
    v_exp_f32 v124, v124
    v_exp_f32 v125, v125
    v_exp_f32 v126, v126
    v_exp_f32 v127, v127
    v_exp_f32 v128, v128
    v_exp_f32 v129, v129
    v_exp_f32 v130, v130
    v_exp_f32 v131, v131
    v_pk_add_f32 v[132:133], v[124:125], s[58:59]
    v_pk_add_f32 v[134:135], v[126:127], s[58:59]
    v_pk_add_f32 v[136:137], v[128:129], s[58:59]
    v_pk_add_f32 v[138:139], v[130:131], s[58:59]
    v_pk_mul_f32 v[124:125], v[124:125], v[132:133]
    v_pk_mul_f32 v[126:127], v[126:127], v[134:135]
    v_pk_mul_f32 v[128:129], v[128:129], v[136:137]
    v_pk_mul_f32 v[130:131], v[130:131], v[138:139]
    v_pk_add_f32 v[132:133], v[124:125], s[58:59]
    v_pk_add_f32 v[134:135], v[126:127], s[58:59]
    v_pk_add_f32 v[136:137], v[128:129], s[58:59]
    v_pk_add_f32 v[138:139], v[130:131], s[58:59]
    v_rcp_f32 v132, v132
    v_rcp_f32 v133, v133
    v_rcp_f32 v134, v134
    v_rcp_f32 v135, v135
    v_rcp_f32 v136, v136
    v_rcp_f32 v137, v137
    v_rcp_f32 v138, v138
    v_rcp_f32 v139, v139
    v_pk_mul_f32 v[124:125], v[124:125], v[132:133]
    v_pk_mul_f32 v[126:127], v[126:127], v[134:135]
    v_pk_mul_f32 v[128:129], v[128:129], v[136:137]
    v_pk_mul_f32 v[130:131], v[130:131], v[138:139]
    v_pk_mul_f32 v[124:125], v[124:125], v[108:109]
    v_pk_mul_f32 v[126:127], v[126:127], v[110:111]
    v_pk_mul_f32 v[128:129], v[128:129], v[112:113]
    v_pk_mul_f32 v[130:131], v[130:131], v[114:115]
    v_cvt_pk_bf16_f32 v148, v124, v125
    v_cvt_pk_bf16_f32 v149, v126, v127
    v_cvt_pk_bf16_f32 v150, v128, v129
    v_cvt_pk_bf16_f32 v151, v130, v131
    v_pk_mul_f32 v[124:125], v[116:117], s[56:57]
    v_pk_mul_f32 v[126:127], v[118:119], s[56:57]
    v_pk_mul_f32 v[128:129], v[120:121], s[56:57]
    v_pk_mul_f32 v[130:131], v[122:123], s[56:57]
    v_min_f32 v124, s50, v124
    v_min_f32 v125, s50, v125
    v_min_f32 v126, s50, v126
    v_min_f32 v127, s50, v127
    v_min_f32 v128, s50, v128
    v_min_f32 v129, s50, v129
    v_min_f32 v130, s50, v130
    v_min_f32 v131, s50, v131
    v_exp_f32 v124, v124
    v_exp_f32 v125, v125
    v_exp_f32 v126, v126
    v_exp_f32 v127, v127
    v_exp_f32 v128, v128
    v_exp_f32 v129, v129
    v_exp_f32 v130, v130
    v_exp_f32 v131, v131
    v_pk_add_f32 v[132:133], v[124:125], s[58:59]
    v_pk_add_f32 v[134:135], v[126:127], s[58:59]
    v_pk_add_f32 v[136:137], v[128:129], s[58:59]
    v_pk_add_f32 v[138:139], v[130:131], s[58:59]
    v_pk_mul_f32 v[124:125], v[124:125], v[132:133]
    v_pk_mul_f32 v[126:127], v[126:127], v[134:135]
    v_pk_mul_f32 v[128:129], v[128:129], v[136:137]
    v_pk_mul_f32 v[130:131], v[130:131], v[138:139]
    v_pk_add_f32 v[132:133], v[124:125], s[58:59]
    v_pk_add_f32 v[134:135], v[126:127], s[58:59]
    v_pk_add_f32 v[136:137], v[128:129], s[58:59]
    v_pk_add_f32 v[138:139], v[130:131], s[58:59]
    v_rcp_f32 v132, v132
    v_rcp_f32 v133, v133
    v_rcp_f32 v134, v134
    v_rcp_f32 v135, v135
    v_rcp_f32 v136, v136
    v_rcp_f32 v137, v137
    v_rcp_f32 v138, v138
    v_rcp_f32 v139, v139
    v_pk_mul_f32 v[124:125], v[124:125], v[132:133]
    v_pk_mul_f32 v[126:127], v[126:127], v[134:135]
    v_pk_mul_f32 v[128:129], v[128:129], v[136:137]
    v_pk_mul_f32 v[130:131], v[130:131], v[138:139]
    v_pk_mul_f32 v[124:125], v[124:125], v[116:117]
    v_pk_mul_f32 v[126:127], v[126:127], v[118:119]
    v_pk_mul_f32 v[128:129], v[128:129], v[120:121]
    v_pk_mul_f32 v[130:131], v[130:131], v[122:123]
    v_cvt_pk_bf16_f32 v152, v124, v125
    v_cvt_pk_bf16_f32 v153, v126, v127
    v_cvt_pk_bf16_f32 v154, v128, v129
    v_cvt_pk_bf16_f32 v155, v130, v131
    ds_write_b128 v2, v[148:151] offset:24576
    ds_write_b128 v2, v[152:155] offset:28672
    s_mov_b64 exec, 1
    v_mov_b32 v4, 163796
    v_mov_b32 v5, 1
    ds_add_u32 v4, v5
    s_mov_b64 exec, -1
    s_branch L_attn_c
L_after_ab0:
    s_setprio 3
    s_cmp_lg_u32 s41, 0
    s_cbranch_scc1 L_attn_c
    s_waitcnt vmcnt(0)
    v_cmp_ne_u32 vcc, 1, v18
    s_lshl_b32 s56, s2, 9
    s_add_u32 s56, s56, 0xf00000
    v_lshlrev_b32 v2, 2, v0
    s_cmp_eq_u64 vcc, 0
    s_cbranch_scc1 L_seen
    s_mov_b32 s48, 0
L_poll_8:
    s_mov_b32 exec_lo, 0xffffffff
    s_mov_b32 exec_hi, 0x0
    buffer_load_dword v3, v2, s[16:19], s56 offen sc1
    s_waitcnt vmcnt(0)
    v_cmp_ne_u32 vcc, 1, v3
    s_add_u32 s48, s48, 1
    s_cmp_eq_u64 vcc, 0
    s_cbranch_scc1 L_polld_9
    s_cmp_ge_u32 s48, 262144
    s_cbranch_scc1 L_polld_9
    s_and_b32 s49, s48, 31
    s_cmp_lg_u32 s49, 0
    s_cbranch_scc1 L_pollf_10
    s_mov_b64 exec, -1
    v_mov_b32 v3, 0
    v_mov_b32 v4, 1
    s_mov_b64 exec, 1
    buffer_store_byte v4, v3, s[24:27], s2 offen sc1
    s_mov_b64 exec, -1
    s_nop 0
    v_lshlrev_b32 v4, 2, v0
    buffer_load_dword v3, v4, s[24:27], 0 offen sc1
    s_waitcnt vmcnt(0)
    v_and_b32 v3, 0x1010101, v3
    v_cmp_ne_u32 vcc, 0x1010101, v3
    s_nop 0
    s_cmp_eq_u64 vcc, 0
    s_cbranch_scc1 L_polld_9
L_pollf_10:
    s_sleep 1
    s_branch L_poll_8
L_polld_9:
    s_mov_b64 exec, -1
L_seen:
    v_mov_b32 v2, 163784
    v_mov_b32 v3, 1
    ds_write_b32 v2, v3
L_attn_c:
    s_lshl3_add_u32 s55, s45, s41
    s_lshl_b32 s48, s41, 10
    s_add_u32 s48, s48, 131072
    v_add_u32 v2, s48, v1
    v_and_b32 v5, 15, v0
    v_lshrrev_b32 v6, 5, v0
    v_lshlrev_b32 v5, 4, v5
    v_lshl_add_u32 v5, v6, 8, v5
    v_add_u32 v7, 65536, v5
    s_mov_b32 s50, 0x0000ffff
    s_mov_b32 s51, 0x0000ffff
    s_mov_b32 s52, 0
    v_and_b32 v5, 27, v0
    v_cmp_eq_u32 vcc, 16, v5
    v_mov_b32 v5, 0x3f803f80
    s_nop 1
    v_cndmask_b32 v5, 0, v5, vcc
    v_mov_b32 v16, v5
    v_mov_b32 v17, v5
    v_mov_b32 v18, v5
    v_mov_b32 v19, v5
    v_mov_b32 v20, v5
    v_mov_b32 v21, v5
    v_mov_b32 v22, v5
    v_mov_b32 v23, v5
    v_mov_b32 v80, 0
    v_mov_b32 v81, 0
    v_mov_b32 v82, 0
    v_mov_b32 v83, 0
    v_mov_b32 v84, 0
    v_mov_b32 v85, 0
    v_mov_b32 v86, 0
    v_mov_b32 v87, 0
    v_mov_b32 v88, 0
    v_mov_b32 v89, 0
    v_mov_b32 v90, 0
    v_mov_b32 v91, 0
    v_mov_b32 v92, 0
    v_mov_b32 v93, 0
    v_mov_b32 v94, 0
    v_mov_b32 v95, 0
    v_mov_b32 v28, 0
    v_mov_b32 v29, 0
    v_mov_b32 v30, 0
    v_mov_b32 v31, 0
    v_mov_b32 v3, v7
    s_mov_b32 s53, 0
    s_mov_b32 s48, 0
    v_mov_b32 v96, 163792
L_cw_11:
    ds_read_b32 v97, v96
    s_waitcnt lgkmcnt(0)
    v_readfirstlane_b32 s49, v97
    s_add_u32 s48, s48, 1
    s_cmp_ge_u32 s49, 4
    s_cbranch_scc1 L_cwd_12
    s_cmp_ge_u32 s48, 2097152
    s_cbranch_scc1 L_cwd_12
    s_sleep 2
    s_branch L_cw_11
L_cwd_12:
    s_setprio 2
    ds_read_b128 v[8:11], v2
    ds_read_b128 v[12:15], v1 offset:0
    v_mov_b32 v2, v1
    s_waitcnt lgkmcnt(0)
    v_mfma_f32_32x32x16_bf16 v[48:63], v[12:15], v[8:11], 0
    ds_read_b128 v[12:15], v1 offset:1024
    s_nop 11
    v_max3_f32 v5, v48, v49, v50
    v_max3_f32 v6, v51, v52, v53
    v_max3_f32 v5, v5, v54, v55
    v_max3_f32 v6, v6, v56, v57
    v_max3_f32 v5, v5, v58, v59
    v_max3_f32 v6, v6, v60, v61
    v_max3_f32 v5, v5, v62, v63
    v_max_f32 v5, v5, v6
    v_max_f32 v6, v5, v5
    s_nop 1
    v_permlane32_swap_b32 v5, v6
    s_nop 1
    v_max_f32 v5, v5, v6
    v_sub_f32 v5, 0, v5
    v_add_f32 v48, v48, v5
    v_add_f32 v49, v49, v5
    v_add_f32 v50, v50, v5
    v_add_f32 v51, v51, v5
    v_add_f32 v52, v52, v5
    v_add_f32 v53, v53, v5
    v_add_f32 v54, v54, v5
    v_add_f32 v55, v55, v5
    v_add_f32 v56, v56, v5
    v_add_f32 v57, v57, v5
    v_add_f32 v58, v58, v5
    v_add_f32 v59, v59, v5
    v_add_f32 v60, v60, v5
    v_add_f32 v61, v61, v5
    v_add_f32 v62, v62, v5
    v_add_f32 v63, v63, v5
    v_mov_b32 v32, v5
    v_mov_b32 v33, v5
    v_mov_b32 v34, v5
    v_mov_b32 v35, v5
    v_mov_b32 v36, v5
    v_mov_b32 v37, v5
    v_mov_b32 v38, v5
    v_mov_b32 v39, v5
    v_mov_b32 v40, v5
    v_mov_b32 v41, v5
    v_mov_b32 v42, v5
    v_mov_b32 v43, v5
    v_mov_b32 v44, v5
    v_mov_b32 v45, v5
    v_mov_b32 v46, v5
    v_mov_b32 v47, v5
    s_mov_b32 s54, 1
    s_branch L_aloop
L_setmax:
    v_mov_b32 v6, v5
    s_nop 1
    v_permlane32_swap_b32 v5, v6
    s_nop 1
    v_max_f32 v5, v5, v6
    v_sub_f32 v5, 0, v5
    v_mov_b32 v32, v5
    v_mov_b32 v33, v5
    v_mov_b32 v34, v5
    v_mov_b32 v35, v5
    v_mov_b32 v36, v5
    v_mov_b32 v37, v5
    v_mov_b32 v38, v5
    v_mov_b32 v39, v5
    v_mov_b32 v40, v5
    v_mov_b32 v41, v5
    v_mov_b32 v42, v5
    v_mov_b32 v43, v5
    v_mov_b32 v44, v5
    v_mov_b32 v45, v5
    v_mov_b32 v46, v5
    v_mov_b32 v47, v5
    v_mov_b32 v80, 0
    v_mov_b32 v81, 0
    v_mov_b32 v82, 0
    v_mov_b32 v83, 0
    v_mov_b32 v84, 0
    v_mov_b32 v85, 0
    v_mov_b32 v86, 0
    v_mov_b32 v87, 0
    v_mov_b32 v88, 0
    v_mov_b32 v89, 0
    v_mov_b32 v90, 0
    v_mov_b32 v91, 0
    v_mov_b32 v92, 0
    v_mov_b32 v93, 0
    v_mov_b32 v94, 0
    v_mov_b32 v95, 0
    v_mov_b32 v2, v1
    v_mov_b32 v3, v7
    ds_read_b128 v[12:15], v2 offset:0
    v_mov_b32 v28, 0
    v_mov_b32 v29, 0
    v_mov_b32 v30, 0
    v_mov_b32 v31, 0
    s_waitcnt lgkmcnt(0)
    v_mfma_f32_32x32x16_bf16 v[48:63], v[12:15], v[8:11], v[32:47]
    ds_read_b128 v[12:15], v2 offset:1024
    s_mov_b32 s53, 0
    s_mov_b32 s54, 4
    s_setprio 2
    s_nop 9
.p2align 6
L_aloop:
    v_exp_f32 v48, v48
    v_exp_f32 v49, v49
    v_mfma_f32_32x32x16_bf16 v[80:95], v[20:23], v[28:31], v[80:95]
    s_mov_b64 exec, s[50:51]
    ds_read_b128 v[16:19], v3 offset:0
    ds_read_b128 v[20:23], v3 offset:512
    s_mov_b64 exec, -1
    v_exp_f32 v50, v50
    v_exp_f32 v51, v51
    v_exp_f32 v52, v52
    v_exp_f32 v53, v53
    v_exp_f32 v54, v54
    v_exp_f32 v55, v55
    s_waitcnt lgkmcnt(2)
    v_mfma_f32_32x32x16_bf16 v[64:79], v[12:15], v[8:11], v[32:47]
    ds_read_b128 v[12:15], v2 offset:2048
    v_cvt_pk_bf16_f32 v24, v48, v49
    v_cvt_pk_bf16_f32 v25, v50, v51
    v_cvt_pk_bf16_f32 v26, v52, v53
    v_exp_f32 v56, v56
    v_cvt_pk_bf16_f32 v27, v54, v55
    v_exp_f32 v57, v57
    v_exp_f32 v58, v58
    v_exp_f32 v59, v59
    s_waitcnt lgkmcnt(1)
    v_mfma_f32_32x32x16_bf16 v[80:95], v[16:19], v[24:27], v[80:95]
    v_exp_f32 v60, v60
    v_exp_f32 v61, v61
    v_exp_f32 v62, v62
    v_exp_f32 v63, v63
    v_cvt_pk_bf16_f32 v28, v56, v57
    v_cvt_pk_bf16_f32 v29, v58, v59
    v_cvt_pk_bf16_f32 v30, v60, v61
    v_cvt_pk_bf16_f32 v31, v62, v63
    v_exp_f32 v64, v64
    v_exp_f32 v65, v65
    v_mfma_f32_32x32x16_bf16 v[80:95], v[20:23], v[28:31], v[80:95]
    s_mov_b64 exec, s[50:51]
    ds_read_b128 v[16:19], v3 offset:1024
    ds_read_b128 v[20:23], v3 offset:1536
    s_mov_b64 exec, -1
    v_exp_f32 v66, v66
    v_exp_f32 v67, v67
    v_exp_f32 v68, v68
    v_exp_f32 v69, v69
    v_exp_f32 v70, v70
    v_exp_f32 v71, v71
    s_waitcnt lgkmcnt(2)
    v_mfma_f32_32x32x16_bf16 v[48:63], v[12:15], v[8:11], v[32:47]
    ds_read_b128 v[12:15], v2 offset:3072
    v_cvt_pk_bf16_f32 v24, v64, v65
    v_cvt_pk_bf16_f32 v25, v66, v67
    v_cvt_pk_bf16_f32 v26, v68, v69
    v_exp_f32 v72, v72
    v_cvt_pk_bf16_f32 v27, v70, v71
    v_exp_f32 v73, v73
    v_exp_f32 v74, v74
    v_exp_f32 v75, v75
    s_waitcnt lgkmcnt(1)
    v_mfma_f32_32x32x16_bf16 v[80:95], v[16:19], v[24:27], v[80:95]
    v_exp_f32 v76, v76
    v_exp_f32 v77, v77
    v_exp_f32 v78, v78
    v_exp_f32 v79, v79
    v_cvt_pk_bf16_f32 v28, v72, v73
    v_cvt_pk_bf16_f32 v29, v74, v75
    v_cvt_pk_bf16_f32 v30, v76, v77
    v_cvt_pk_bf16_f32 v31, v78, v79
    v_exp_f32 v48, v48
    v_exp_f32 v49, v49
    v_mfma_f32_32x32x16_bf16 v[80:95], v[20:23], v[28:31], v[80:95]
    s_mov_b64 exec, s[50:51]
    ds_read_b128 v[16:19], v3 offset:2048
    ds_read_b128 v[20:23], v3 offset:2560
    s_mov_b64 exec, -1
    v_exp_f32 v50, v50
    v_exp_f32 v51, v51
    v_exp_f32 v52, v52
    v_exp_f32 v53, v53
    v_exp_f32 v54, v54
    v_exp_f32 v55, v55
    s_waitcnt lgkmcnt(2)
    v_mfma_f32_32x32x16_bf16 v[64:79], v[12:15], v[8:11], v[32:47]
    ds_read_b128 v[12:15], v2 offset:4096
    v_cvt_pk_bf16_f32 v24, v48, v49
    v_cvt_pk_bf16_f32 v25, v50, v51
    v_cvt_pk_bf16_f32 v26, v52, v53
    v_exp_f32 v56, v56
    v_cvt_pk_bf16_f32 v27, v54, v55
    v_exp_f32 v57, v57
    v_exp_f32 v58, v58
    v_exp_f32 v59, v59
    s_waitcnt lgkmcnt(1)
    v_mfma_f32_32x32x16_bf16 v[80:95], v[16:19], v[24:27], v[80:95]
    v_exp_f32 v60, v60
    v_exp_f32 v61, v61
    v_exp_f32 v62, v62
    v_exp_f32 v63, v63
    v_cvt_pk_bf16_f32 v28, v56, v57
    v_cvt_pk_bf16_f32 v29, v58, v59
    v_cvt_pk_bf16_f32 v30, v60, v61
    v_cvt_pk_bf16_f32 v31, v62, v63
    v_exp_f32 v64, v64
    v_exp_f32 v65, v65
    v_mfma_f32_32x32x16_bf16 v[80:95], v[20:23], v[28:31], v[80:95]
    s_mov_b64 exec, s[50:51]
    ds_read_b128 v[16:19], v3 offset:3072
    ds_read_b128 v[20:23], v3 offset:3584
    s_mov_b64 exec, -1
    v_exp_f32 v66, v66
    v_exp_f32 v67, v67
    v_exp_f32 v68, v68
    v_exp_f32 v69, v69
    v_exp_f32 v70, v70
    v_exp_f32 v71, v71
    s_waitcnt lgkmcnt(2)
    v_mfma_f32_32x32x16_bf16 v[48:63], v[12:15], v[8:11], v[32:47]
    ds_read_b128 v[12:15], v2 offset:5120
    v_cvt_pk_bf16_f32 v24, v64, v65
    v_cvt_pk_bf16_f32 v25, v66, v67
    v_cvt_pk_bf16_f32 v26, v68, v69
    v_exp_f32 v72, v72
    v_cvt_pk_bf16_f32 v27, v70, v71
    v_exp_f32 v73, v73
    v_exp_f32 v74, v74
    v_exp_f32 v75, v75
    s_waitcnt lgkmcnt(1)
    v_mfma_f32_32x32x16_bf16 v[80:95], v[16:19], v[24:27], v[80:95]
    v_exp_f32 v76, v76
    v_exp_f32 v77, v77
    v_exp_f32 v78, v78
    v_exp_f32 v79, v79
    v_cvt_pk_bf16_f32 v28, v72, v73
    v_cvt_pk_bf16_f32 v29, v74, v75
    v_cvt_pk_bf16_f32 v30, v76, v77
    v_cvt_pk_bf16_f32 v31, v78, v79
    v_exp_f32 v48, v48
    v_exp_f32 v49, v49
    v_mfma_f32_32x32x16_bf16 v[80:95], v[20:23], v[28:31], v[80:95]
    s_mov_b64 exec, s[50:51]
    ds_read_b128 v[16:19], v3 offset:4096
    ds_read_b128 v[20:23], v3 offset:4608
    s_mov_b64 exec, -1
    v_exp_f32 v50, v50
    v_exp_f32 v51, v51
    v_exp_f32 v52, v52
    v_exp_f32 v53, v53
    v_exp_f32 v54, v54
    v_exp_f32 v55, v55
    s_waitcnt lgkmcnt(2)
    v_mfma_f32_32x32x16_bf16 v[64:79], v[12:15], v[8:11], v[32:47]
    ds_read_b128 v[12:15], v2 offset:6144
    v_cvt_pk_bf16_f32 v24, v48, v49
    v_cvt_pk_bf16_f32 v25, v50, v51
    v_cvt_pk_bf16_f32 v26, v52, v53
    v_exp_f32 v56, v56
    v_cvt_pk_bf16_f32 v27, v54, v55
    v_exp_f32 v57, v57
    v_exp_f32 v58, v58
    v_exp_f32 v59, v59
    s_waitcnt lgkmcnt(1)
    v_mfma_f32_32x32x16_bf16 v[80:95], v[16:19], v[24:27], v[80:95]
    v_exp_f32 v60, v60
    v_exp_f32 v61, v61
    v_exp_f32 v62, v62
    v_exp_f32 v63, v63
    v_cvt_pk_bf16_f32 v28, v56, v57
    v_cvt_pk_bf16_f32 v29, v58, v59
    v_cvt_pk_bf16_f32 v30, v60, v61
    v_cvt_pk_bf16_f32 v31, v62, v63
    v_exp_f32 v64, v64
    v_exp_f32 v65, v65
    v_mfma_f32_32x32x16_bf16 v[80:95], v[20:23], v[28:31], v[80:95]
    s_mov_b64 exec, s[50:51]
    ds_read_b128 v[16:19], v3 offset:5120
    ds_read_b128 v[20:23], v3 offset:5632
    s_mov_b64 exec, -1
    v_exp_f32 v66, v66
    v_exp_f32 v67, v67
    v_exp_f32 v68, v68
    v_exp_f32 v69, v69
    v_exp_f32 v70, v70
    v_exp_f32 v71, v71
    s_waitcnt lgkmcnt(2)
    v_mfma_f32_32x32x16_bf16 v[48:63], v[12:15], v[8:11], v[32:47]
    ds_read_b128 v[12:15], v2 offset:7168
    v_cvt_pk_bf16_f32 v24, v64, v65
    v_cvt_pk_bf16_f32 v25, v66, v67
    v_cvt_pk_bf16_f32 v26, v68, v69
    v_exp_f32 v72, v72
    v_cvt_pk_bf16_f32 v27, v70, v71
    v_exp_f32 v73, v73
    v_exp_f32 v74, v74
    v_exp_f32 v75, v75
    s_waitcnt lgkmcnt(1)
    v_mfma_f32_32x32x16_bf16 v[80:95], v[16:19], v[24:27], v[80:95]
    v_exp_f32 v76, v76
    v_exp_f32 v77, v77
    v_exp_f32 v78, v78
    v_exp_f32 v79, v79
    v_cvt_pk_bf16_f32 v28, v72, v73
    v_cvt_pk_bf16_f32 v29, v74, v75
    v_cvt_pk_bf16_f32 v30, v76, v77
    v_cvt_pk_bf16_f32 v31, v78, v79
    v_exp_f32 v48, v48
    v_exp_f32 v49, v49
    v_mfma_f32_32x32x16_bf16 v[80:95], v[20:23], v[28:31], v[80:95]
    s_mov_b64 exec, s[50:51]
    ds_read_b128 v[16:19], v3 offset:6144
    ds_read_b128 v[20:23], v3 offset:6656
    s_mov_b64 exec, -1
    v_exp_f32 v50, v50
    v_exp_f32 v51, v51
    v_exp_f32 v52, v52
    v_exp_f32 v53, v53
    v_exp_f32 v54, v54
    v_exp_f32 v55, v55
    s_waitcnt lgkmcnt(2)
    v_mfma_f32_32x32x16_bf16 v[64:79], v[12:15], v[8:11], v[32:47]
    ds_read_b128 v[12:15], v2 offset:8192
    v_cvt_pk_bf16_f32 v24, v48, v49
    v_cvt_pk_bf16_f32 v25, v50, v51
    v_cvt_pk_bf16_f32 v26, v52, v53
    v_exp_f32 v56, v56
    v_cvt_pk_bf16_f32 v27, v54, v55
    v_exp_f32 v57, v57
    v_exp_f32 v58, v58
    v_exp_f32 v59, v59
    s_waitcnt lgkmcnt(1)
    v_mfma_f32_32x32x16_bf16 v[80:95], v[16:19], v[24:27], v[80:95]
    v_exp_f32 v60, v60
    v_exp_f32 v61, v61
    v_exp_f32 v62, v62
    v_exp_f32 v63, v63
    v_cvt_pk_bf16_f32 v28, v56, v57
    v_cvt_pk_bf16_f32 v29, v58, v59
    v_cvt_pk_bf16_f32 v30, v60, v61
    v_cvt_pk_bf16_f32 v31, v62, v63
    v_exp_f32 v64, v64
    v_exp_f32 v65, v65
    v_mfma_f32_32x32x16_bf16 v[80:95], v[20:23], v[28:31], v[80:95]
    s_mov_b64 exec, s[50:51]
    ds_read_b128 v[16:19], v3 offset:7168
    ds_read_b128 v[20:23], v3 offset:7680
    s_mov_b64 exec, -1
    v_exp_f32 v66, v66
    v_exp_f32 v67, v67
    v_exp_f32 v68, v68
    v_exp_f32 v69, v69
    v_exp_f32 v70, v70
    v_exp_f32 v71, v71
    s_waitcnt lgkmcnt(2)
    v_mfma_f32_32x32x16_bf16 v[48:63], v[12:15], v[8:11], v[32:47]
    ds_read_b128 v[12:15], v2 offset:9216
    v_cvt_pk_bf16_f32 v24, v64, v65
    v_cvt_pk_bf16_f32 v25, v66, v67
    v_cvt_pk_bf16_f32 v26, v68, v69
    v_exp_f32 v72, v72
    v_cvt_pk_bf16_f32 v27, v70, v71
    v_exp_f32 v73, v73
    v_exp_f32 v74, v74
    v_exp_f32 v75, v75
    s_waitcnt lgkmcnt(1)
    v_mfma_f32_32x32x16_bf16 v[80:95], v[16:19], v[24:27], v[80:95]
    v_exp_f32 v76, v76
    v_exp_f32 v77, v77
    v_exp_f32 v78, v78
    v_exp_f32 v79, v79
    s_add_u32 s53, s53, 1
    s_cmp_lt_u32 s53, s54
    v_cvt_pk_bf16_f32 v28, v72, v73
    v_cvt_pk_bf16_f32 v29, v74, v75
    v_cvt_pk_bf16_f32 v30, v76, v77
    v_cvt_pk_bf16_f32 v31, v78, v79
    v_add_u32 v2, 8192, v2
    v_add_u32 v3, 8192, v3
    s_cbranch_scc1 L_aloop
    s_cmp_eq_u32 s53, 1
    s_cbranch_scc0 L_seg2
    s_mov_b32 s54, 4
    s_mov_b32 s48, 0
    v_mov_b32 v96, 163800
L_cw_13:
    ds_read_b32 v97, v96
    s_waitcnt lgkmcnt(0)
    v_readfirstlane_b32 s49, v97
    s_add_u32 s48, s48, 1
    s_cmp_ge_u32 s49, 4
    s_cbranch_scc1 L_cwd_14
    s_cmp_ge_u32 s48, 2097152
    s_cbranch_scc1 L_cwd_14
    s_sleep 1
    s_branch L_cw_13
L_cwd_14:
    s_mov_b64 exec, 1
    v_mov_b32 v96, 163804
    v_mov_b32 v97, 1
    ds_add_u32 v96, v97
    s_mov_b64 exec, -1
    s_branch L_aloop
L_seg2:
    s_cmp_eq_u32 s53, 4
    s_cbranch_scc0 L_seg3
    s_mov_b32 s54, 7
    s_setprio 1
    v_and_b32 v96, 31, v0
    v_lshlrev_b32 v96, 2, v96
    s_lshl_b32 s48, s55, 7
    s_lshl_b32 s49, s36, 13
    s_add_u32 s48, s48, s49
    s_add_u32 s48, s48, 0xe00000
    buffer_load_dword v4, v96, s[16:19], s48 offen
    s_branch L_aloop
L_seg3:
    s_cmp_eq_u32 s53, 7
    s_cbranch_scc0 L_adone
    s_mov_b32 s54, 8
    s_setprio 0
    s_branch L_aloop
L_adone:
    v_mfma_f32_32x32x16_bf16 v[80:95], v[20:23], v[28:31], v[80:95]
    s_waitcnt lgkmcnt(0)
    s_nop 13
    v_max3_f32 v5, abs(v80), abs(v81), abs(v82)
    v_max3_f32 v5, v5, abs(v83), abs(v84)
    v_max3_f32 v5, v5, abs(v85), abs(v86)
    v_max_f32 v5, v5, abs(v87)
    v_add_f32 v6, v80, v81
    v_add_f32 v6, v6, v82
    v_add_f32 v6, v6, v83
    v_add_f32 v6, v6, v84
    v_add_f32 v6, v6, v85
    v_add_f32 v6, v6, v86
    v_add_f32 v6, v6, v87
    s_mov_b32 s48, 0x5f800000
    s_mov_b32 s49, 0x7b800000
    v_cmp_nlt_f32 vcc, v88, s48
    v_cmp_nlt_f32 s[56:57], v5, s49
    v_cmp_u_f32 s[58:59], v6, v6
    s_or_b64 vcc, vcc, s[56:57]
    s_or_b64 vcc, vcc, s[58:59]
    s_cmp_eq_u64 vcc, 0
    s_cbranch_scc1 L_fin
    s_cmp_eq_u32 s52, 0
    s_cbranch_scc0 L_fin
    s_mov_b32 s52, 1
    s_mov_b32 s53, 0
    v_mov_b32 v2, v1
    v_mov_b32 v5, 0xff800000
L_maxloop:
    ds_read_b128 v[12:15], v2 offset:0
    s_waitcnt lgkmcnt(0)
    v_mfma_f32_32x32x16_bf16 v[48:63], v[12:15], v[8:11], 0
    v_add_u32 v2, 1024, v2
    s_nop 15
    v_max3_f32 v5, v5, v48, v49
    v_max3_f32 v5, v5, v50, v51
    v_max3_f32 v5, v5, v52, v53
    v_max3_f32 v5, v5, v54, v55
    v_max3_f32 v5, v5, v56, v57
    v_max3_f32 v5, v5, v58, v59
    v_max3_f32 v5, v5, v60, v61
    v_max3_f32 v5, v5, v62, v63
    s_add_u32 s53, s53, 1
    s_cmp_lt_u32 s53, 64
    s_cbranch_scc1 L_maxloop
    s_branch L_setmax
L_fin:
    v_rcp_f32 v5, v88
    s_lshl_b32 s48, s55, 15
    s_lshl_b32 s49, s44, 10
    s_add_u32 s48, s48, s49
    s_add_u32 s48, s48, 0x1000000
    s_waitcnt vmcnt(0)
    v_mul_f32 v5, v5, v4
    v_mul_f32 v80, v80, v5
    v_mul_f32 v81, v81, v5
    v_mul_f32 v82, v82, v5
    v_mul_f32 v83, v83, v5
    v_mul_f32 v84, v84, v5
    v_mul_f32 v85, v85, v5
    v_mul_f32 v86, v86, v5
    v_mul_f32 v87, v87, v5
    v_cvt_pk_bf16_f32 v80, v80, v81
    v_cvt_pk_bf16_f32 v81, v82, v83
    v_cvt_pk_bf16_f32 v82, v84, v85
    v_cvt_pk_bf16_f32 v83, v86, v87
    v_min_u32 v80, 0xfffffffe, v80
    v_min_u32 v81, 0xfffffffe, v81
    v_min_u32 v82, 0xfffffffe, v82
    v_min_u32 v83, 0xfffffffe, v83
    buffer_store_dwordx4 v[80:83], v1, s[16:19], s48 offen sc1
    s_endpgm
L_after_ab1:
    s_mov_b32 s28, s72
    s_and_b32 s29, s73, 0xffff
    s_mov_b32 s30, 0x1c0000
    s_mov_b32 s31, 0x00020000
    s_mov_b32 s32, s64
    s_and_b32 s33, s65, 0xffff
    s_mov_b32 s34, 0x80000
    s_mov_b32 s35, 0x00020000
    s_mov_b32 s20, s76
    s_and_b32 s21, s77, 0xffff
    s_mov_b32 s22, 0x200000
    s_mov_b32 s23, 0x00020000
    s_setprio 3
    s_and_b32 s50, s41, 3
    s_lshl_b32 s52, s44, 16
    s_lshl_b32 s53, s50, 10
    s_add_u32 s52, s52, s53
    s_mov_b32 s48, 0
    v_mov_b32 v2, 163784
L_wl_15:
    ds_read_b32 v3, v2
    s_waitcnt lgkmcnt(0)
    v_readfirstlane_b32 s49, v3
    s_add_u32 s48, s48, 1
    s_cmp_lg_u32 s49, 0
    s_cbranch_scc1 L_wld_16
    s_cmp_ge_u32 s48, 2097152
    s_cbranch_scc1 L_wld_16
    s_sleep 1
    s_branch L_wl_15
L_wld_16:
    s_lshl_b32 s56, s44, 16
    s_and_b32 s57, s41, 3
    s_lshl_b32 s57, s57, 10
    s_add_u32 s56, s56, s57
    s_add_u32 s58, s45, 1
    s_and_b32 s58, s58, 7
    s_lshl_b32 s58, s58, 13
    s_add_u32 s58, s58, s56
    s_lshl_b32 s48, s45, 13
    s_add_u32 s56, s56, s48
    s_add_u32 m0, s57, 131072
    s_add_u32 s48, s56, 0x0
    buffer_load_dwordx4 v1, s[16:19], s48 offen lds
    s_add_u32 m0, s57, 135168
    s_add_u32 s48, s56, 0x1000
    buffer_load_dwordx4 v1, s[16:19], s48 offen lds
    s_add_u32 m0, s57, 0
    s_add_u32 s48, s56, 0x200000
    buffer_load_dwordx4 v1, s[16:19], s48 offen lds
    s_add_u32 m0, s57, 65536
    s_add_u32 s48, s56, 0x400000
    buffer_load_dwordx4 v1, s[16:19], s48 offen lds
    s_add_u32 m0, s57, 4096
    s_add_u32 s48, s56, 0x201000
    buffer_load_dwordx4 v1, s[16:19], s48 offen lds
    s_add_u32 m0, s57, 69632
    s_add_u32 s48, s56, 0x401000
    buffer_load_dwordx4 v1, s[16:19], s48 offen lds
    s_add_u32 m0, s57, 8192
    s_add_u32 s48, s58, 0x200000
    buffer_load_dwordx4 v1, s[16:19], s48 offen lds
    s_add_u32 m0, s57, 73728
    s_add_u32 s48, s58, 0x400000
    buffer_load_dwordx4 v1, s[16:19], s48 offen lds
    s_add_u32 m0, s57, 12288
    s_add_u32 s48, s58, 0x201000
    buffer_load_dwordx4 v1, s[16:19], s48 offen lds
    s_add_u32 m0, s57, 77824
    s_add_u32 s48, s58, 0x401000
    buffer_load_dwordx4 v1, s[16:19], s48 offen lds
    s_waitcnt vmcnt(0)
    s_mov_b64 exec, 1
    v_mov_b32 v2, 163792
    v_mov_b32 v3, 1
    ds_add_u32 v2, v3
    s_mov_b64 exec, -1
    s_add_u32 s49, s45, 2
    s_and_b32 s49, s49, 7
    s_lshl_b32 s49, s49, 13
    s_add_u32 s49, s49, s52
    s_add_u32 m0, s53, 16384
    s_add_u32 s48, s49, 0x200000
    buffer_load_dwordx4 v1, s[16:19], s48 offen lds
    s_add_u32 m0, s53, 81920
    s_add_u32 s48, s49, 0x400000
    buffer_load_dwordx4 v1, s[16:19], s48 offen lds
    s_add_u32 m0, s53, 20480
    s_add_u32 s48, s49, 0x201000
    buffer_load_dwordx4 v1, s[16:19], s48 offen lds
    s_add_u32 m0, s53, 86016
    s_add_u32 s48, s49, 0x401000
    buffer_load_dwordx4 v1, s[16:19], s48 offen lds
    s_add_u32 s49, s45, 3
    s_and_b32 s49, s49, 7
    s_lshl_b32 s49, s49, 13
    s_add_u32 s49, s49, s52
    s_add_u32 m0, s53, 24576
    s_add_u32 s48, s49, 0x200000
    buffer_load_dwordx4 v1, s[16:19], s48 offen lds
    s_add_u32 m0, s53, 90112
    s_add_u32 s48, s49, 0x400000
    buffer_load_dwordx4 v1, s[16:19], s48 offen lds
    s_add_u32 m0, s53, 28672
    s_add_u32 s48, s49, 0x201000
    buffer_load_dwordx4 v1, s[16:19], s48 offen lds
    s_add_u32 m0, s53, 94208
    s_add_u32 s48, s49, 0x401000
    buffer_load_dwordx4 v1, s[16:19], s48 offen lds
    s_add_u32 s49, s45, 4
    s_and_b32 s49, s49, 7
    s_lshl_b32 s49, s49, 13
    s_add_u32 s49, s49, s52
    s_add_u32 m0, s53, 98304
    s_add_u32 s48, s49, 0x400000
    buffer_load_dwordx4 v1, s[16:19], s48 offen lds
    s_add_u32 m0, s53, 102400
    s_add_u32 s48, s49, 0x401000
    buffer_load_dwordx4 v1, s[16:19], s48 offen lds
    s_add_u32 s49, s45, 5
    s_and_b32 s49, s49, 7
    s_lshl_b32 s49, s49, 13
    s_add_u32 s49, s49, s52
    s_add_u32 m0, s53, 106496
    s_add_u32 s48, s49, 0x400000
    buffer_load_dwordx4 v1, s[16:19], s48 offen lds
    s_add_u32 m0, s53, 110592
    s_add_u32 s48, s49, 0x401000
    buffer_load_dwordx4 v1, s[16:19], s48 offen lds
    s_add_u32 s49, s45, 6
    s_and_b32 s49, s49, 7
    s_lshl_b32 s49, s49, 13
    s_add_u32 s49, s49, s52
    s_add_u32 m0, s53, 114688
    s_add_u32 s48, s49, 0x400000
    buffer_load_dwordx4 v1, s[16:19], s48 offen lds
    s_add_u32 m0, s53, 118784
    s_add_u32 s48, s49, 0x401000
    buffer_load_dwordx4 v1, s[16:19], s48 offen lds
    s_add_u32 s49, s45, 7
    s_and_b32 s49, s49, 7
    s_lshl_b32 s49, s49, 13
    s_add_u32 s49, s49, s52
    s_add_u32 m0, s53, 122880
    s_add_u32 s48, s49, 0x400000
    buffer_load_dwordx4 v1, s[16:19], s48 offen lds
    s_add_u32 m0, s53, 126976
    s_add_u32 s48, s49, 0x401000
    buffer_load_dwordx4 v1, s[16:19], s48 offen lds
    s_mov_b32 s48, 0
    v_mov_b32 v2, 163796
L_cw_17:
    ds_read_b32 v3, v2
    s_waitcnt lgkmcnt(0)
    v_readfirstlane_b32 s49, v3
    s_add_u32 s48, s48, 1
    s_cmp_ge_u32 s49, 4
    s_cbranch_scc1 L_cwd_18
    s_cmp_ge_u32 s48, 2097152
    s_cbranch_scc1 L_cwd_18
    s_sleep 1
    s_branch L_cw_17
L_cwd_18:
    s_add_u32 s48, s53, 32768
    v_add_u32 v2, s48, v1
    ds_read_b128 v[104:107], v2 offset:0
    ds_read_b128 v[108:111], v2 offset:4096
    ds_read_b128 v[112:115], v2 offset:8192
    ds_read_b128 v[116:119], v2 offset:12288
    ds_read_b128 v[120:123], v2 offset:16384
    ds_read_b128 v[124:127], v2 offset:20480
    ds_read_b128 v[128:131], v2 offset:24576
    ds_read_b128 v[132:135], v2 offset:28672
    s_waitcnt lgkmcnt(0)
    s_add_u32 s49, s45, 4
    s_and_b32 s49, s49, 7
    s_lshl_b32 s49, s49, 13
    s_add_u32 s49, s49, s52
    s_add_u32 m0, s53, 32768
    s_add_u32 s48, s49, 0x200000
    buffer_load_dwordx4 v1, s[16:19], s48 offen lds
    s_add_u32 m0, s53, 36864
    s_add_u32 s48, s49, 0x201000
    buffer_load_dwordx4 v1, s[16:19], s48 offen lds
    s_add_u32 s49, s45, 5
    s_and_b32 s49, s49, 7
    s_lshl_b32 s49, s49, 13
    s_add_u32 s49, s49, s52
    s_add_u32 m0, s53, 40960
    s_add_u32 s48, s49, 0x200000
    buffer_load_dwordx4 v1, s[16:19], s48 offen lds
    s_add_u32 m0, s53, 45056
    s_add_u32 s48, s49, 0x201000
    buffer_load_dwordx4 v1, s[16:19], s48 offen lds
    s_add_u32 s49, s45, 6
    s_and_b32 s49, s49, 7
    s_lshl_b32 s49, s49, 13
    s_add_u32 s49, s49, s52
    s_add_u32 m0, s53, 49152
    s_add_u32 s48, s49, 0x200000
    buffer_load_dwordx4 v1, s[16:19], s48 offen lds
    s_add_u32 m0, s53, 53248
    s_add_u32 s48, s49, 0x201000
    buffer_load_dwordx4 v1, s[16:19], s48 offen lds
    s_add_u32 s49, s45, 7
    s_and_b32 s49, s49, 7
    s_lshl_b32 s49, s49, 13
    s_add_u32 s49, s49, s52
    s_add_u32 m0, s53, 57344
    s_add_u32 s48, s49, 0x200000
    buffer_load_dwordx4 v1, s[16:19], s48 offen lds
    s_add_u32 m0, s53, 61440
    s_add_u32 s48, s49, 0x201000
    buffer_load_dwordx4 v1, s[16:19], s48 offen lds
    s_lshl2_add_u32 s56, s38, s50
    s_xor_b32 s57, s56, 1
    s_mul_i32 s56, s56, 112
    s_mul_i32 s57, s57, 112
    s_and_b32 s48, s50, 1
    s_add_u32 s58, s42, s48
    s_mul_i32 s48, s48, s40
    s_add_u32 s59, s43, s48
    s_lshl1_add_u32 s48, s58, s56
    s_lshl_b32 s48, s48, 10
    s_add_u32 s48, s48, 0x600000
    buffer_store_dwordx4 v[104:107], v1, s[16:19], s48 offen sc1
    buffer_store_dwordx4 v[108:111], v1, s[16:19], s48 offen offset:1024 sc1
    s_lshl1_add_u32 s48, s58, s57
    s_lshl_b32 s48, s48, 10
    s_add_u32 s48, s48, 0x600000
    buffer_store_dwordx4 v[112:115], v1, s[16:19], s48 offen sc1
    buffer_store_dwordx4 v[116:119], v1, s[16:19], s48 offen offset:1024 sc1
    s_lshl1_add_u32 s48, s59, s56
    s_lshl_b32 s48, s48, 10
    s_add_u32 s48, s48, 0x600000
    buffer_store_dwordx4 v[120:123], v1, s[16:19], s48 offen sc1
    buffer_store_dwordx4 v[124:127], v1, s[16:19], s48 offen offset:1024 sc1
    s_waitcnt vmcnt(6)
    s_mov_b64 exec, 1
    v_mov_b32 v2, 163800
    v_mov_b32 v3, 1
    ds_add_u32 v2, v3
    s_mov_b64 exec, -1
    s_cmp_eq_u32 s40, 0
    s_cbranch_scc1 L_nohst
    s_lshl1_add_u32 s48, s59, s57
    s_lshl_b32 s48, s48, 10
    s_add_u32 s48, s48, 0x600000
    buffer_store_dwordx4 v[128:131], v1, s[16:19], s48 offen sc1
    buffer_store_dwordx4 v[132:135], v1, s[16:19], s48 offen offset:1024 sc1
L_nohst:
    s_lshl3_add_u32 s48, s45, s50
    s_lshl_b32 s48, s48, 15
    s_lshl_b32 s49, s44, 10
    s_add_u32 s48, s48, s49
    s_add_u32 s48, s48, 0x1000000
    s_add_u32 s49, s48, 131072
    v_mov_b32 v8, -1
    v_mov_b32 v9, -1
    v_mov_b32 v10, -1
    v_mov_b32 v11, -1
    buffer_store_dwordx4 v[8:11], v1, s[16:19], s48 offen sc1
    buffer_store_dwordx4 v[8:11], v1, s[16:19], s49 offen sc1
    v_bfe_u32 v2, v0, 2, 3
    v_lshrrev_b32 v3, 5, v0
    v_and_b32 v4, 3, v0
    v_lshlrev_b32 v7, 4, v4
    v_lshl_add_u32 v7, v3, 6, v7
    v_lshl_add_u32 v5, v2, 10, v7
    v_bfe_u32 v2, v0, 2, 2
    v_lshl_add_u32 v2, v3, 2, v2
    v_lshlrev_b32 v2, 6, v2
    v_lshl_add_u32 v2, v4, 3, v2
    v_bfe_u32 v7, v0, 4, 1
    v_lshl_add_u32 v2, v7, 5, v2
    s_lshl_b32 s51, s50, 13
    s_add_u32 s51, s51, 131072
    v_add_u32 v6, s51, v2
    s_mul_i32 s52, s50, 458752
    s_lshl_b32 s48, s47, 7
    s_add_u32 s52, s52, s48
    s_mul_i32 s53, s46, 224
    s_mul_i32 s48, s50, 28
    s_add_u32 s53, s53, s48
    s_lshl_b32 s53, s53, 10
    s_add_u32 s53, s53, 0x600000
    s_add_u32 s54, s53, 114688
    s_lshl_b32 s57, s50, 17
    s_lshl_b32 s48, s47, 7
    s_add_u32 s57, s57, s48
    s_mul_i32 s56, s47, 7
    s_lshr_b32 s56, s56, 1
    s_and_b32 s48, s46, 3
    s_mul_i32 s48, s48, 7
    s_add_u32 s56, s56, s48
    s_sub_u32 s48, s56, 28
    s_cmp_ge_u32 s56, 28
    s_cselect_b32 s56, s48, s56
    s_and_b32 s56, s56, -1
    s_waitcnt vmcnt(0)
    v_lshlrev_b32 v2, 12, v0
    v_mov_b32 v3, 1
    s_lshr_b32 s48, s38, 1
    s_and_b32 s49, s38, 1
    s_lshl_b32 s49, s49, 7
    s_add_u32 s48, s48, s49
    s_lshl_b32 s48, s48, 9
    s_lshl3_add_u32 s49, s40, s39
    s_lshl4_add_u32 s48, s49, s48
    s_and_b32 s49, s41, 3
    s_lshl2_add_u32 s48, s49, s48
    s_add_u32 s48, s48, 0xf00100
    s_mov_b64 exec, 0xffff
    buffer_store_dword v3, v2, s[16:19], s48 offen sc1
    s_mov_b64 exec, -1
    s_mov_b32 s48, 0
    v_mov_b32 v2, 163804
L_cw_19:
    ds_read_b32 v3, v2
    s_waitcnt lgkmcnt(0)
    v_readfirstlane_b32 s49, v3
    s_add_u32 s48, s48, 1
    s_cmp_ge_u32 s49, 8
    s_cbranch_scc1 L_cwd_20
    s_cmp_ge_u32 s48, 2097152
    s_cbranch_scc1 L_cwd_20
    s_sleep 4
    s_branch L_cw_19
L_cwd_20:
    s_mov_b64 exec, 1
    v_mov_b32 v2, 163788
    v_mov_b32 v3, 1
    ds_add_rtn_u32 v3, v2, v3
    s_waitcnt lgkmcnt(0)
    v_readfirstlane_b32 s48, v3
    s_mov_b64 exec, -1
    s_cmp_eq_u32 s48, 3
    s_cbranch_scc0 L_norec
    v_mov_b32 v2, 0
    v_mov_b32 v3, 3
    s_mov_b64 exec, 1
    buffer_store_byte v3, v2, s[24:27], s2 offen sc1
    s_mov_b64 exec, -1
    s_branch L_recd
L_norec:
    s_cmp_eq_u32 s50, 3
    s_cbranch_scc0 L_recd
    s_mov_b32 s49, 0
    v_mov_b32 v2, 163788
L_cntw:
    ds_read_b32 v3, v2
    s_waitcnt lgkmcnt(0)
    v_readfirstlane_b32 s48, v3
    s_add_u32 s49, s49, 1
    s_cmp_eq_u32 s48, 4
    s_cbranch_scc1 L_recd
    s_cmp_ge_u32 s49, 2097152
    s_cbranch_scc1 L_recd
    s_sleep 1
    s_branch L_cntw
L_recd:
    s_add_u32 m0, s51, 0
    s_add_u32 s48, s57, 0
    buffer_load_dwordx4 v5, s[32:35], s48 offen lds
    s_add_u32 m0, s51, 1024
    s_add_u32 s48, s57, 8192
    buffer_load_dwordx4 v5, s[32:35], s48 offen lds
    s_add_u32 m0, s51, 2048
    s_add_u32 s48, s57, 16384
    buffer_load_dwordx4 v5, s[32:35], s48 offen lds
    s_add_u32 m0, s51, 3072
    s_add_u32 s48, s57, 24576
    buffer_load_dwordx4 v5, s[32:35], s48 offen lds
    s_add_u32 m0, s51, 4096
    s_add_u32 s48, s57, 32768
    buffer_load_dwordx4 v5, s[32:35], s48 offen lds
    s_add_u32 m0, s51, 5120
    s_add_u32 s48, s57, 40960
    buffer_load_dwordx4 v5, s[32:35], s48 offen lds
    s_add_u32 m0, s51, 6144
    s_add_u32 s48, s57, 49152
    buffer_load_dwordx4 v5, s[32:35], s48 offen lds
    s_add_u32 m0, s51, 7168
    s_add_u32 s48, s57, 57344
    buffer_load_dwordx4 v5, s[32:35], s48 offen lds
    s_waitcnt vmcnt(0)
    ds_read_b64_tr_b16 v[72:73], v6 offset:0
    ds_read_b64_tr_b16 v[74:75], v6 offset:1024
    ds_read_b64_tr_b16 v[76:77], v6 offset:512
    ds_read_b64_tr_b16 v[78:79], v6 offset:1536
    ds_read_b64_tr_b16 v[80:81], v6 offset:2048
    ds_read_b64_tr_b16 v[82:83], v6 offset:3072
    ds_read_b64_tr_b16 v[84:85], v6 offset:2560
    ds_read_b64_tr_b16 v[86:87], v6 offset:3584
    ds_read_b64_tr_b16 v[88:89], v6 offset:4096
    ds_read_b64_tr_b16 v[90:91], v6 offset:5120
    ds_read_b64_tr_b16 v[92:93], v6 offset:4608
    ds_read_b64_tr_b16 v[94:95], v6 offset:5632
    ds_read_b64_tr_b16 v[96:97], v6 offset:6144
    ds_read_b64_tr_b16 v[98:99], v6 offset:7168
    ds_read_b64_tr_b16 v[100:101], v6 offset:6656
    ds_read_b64_tr_b16 v[102:103], v6 offset:7680
    s_waitcnt lgkmcnt(0)
    s_lshl_b32 s55, s2, 9
    s_add_u32 s55, s55, 0xf00100
    v_lshlrev_b32 v2, 2, v0
    s_mov_b32 s48, 0
L_poll_21:
    s_mov_b32 exec_lo, 0xffffffff
    s_mov_b32 exec_hi, 0xffffffff
    buffer_load_dword v3, v2, s[16:19], s55 offen sc1
    s_waitcnt vmcnt(0)
    v_cmp_ne_u32 vcc, 1, v3
    s_add_u32 s48, s48, 1
    s_cmp_eq_u64 vcc, 0
    s_cbranch_scc1 L_polld_22
    s_cmp_ge_u32 s48, 262144
    s_cbranch_scc1 L_polld_22
    s_and_b32 s49, s48, 31
    s_cmp_lg_u32 s49, 0
    s_cbranch_scc1 L_pollf_23
    s_mov_b64 exec, -1
    v_lshlrev_b32 v4, 2, v0
    buffer_load_dword v3, v4, s[24:27], 0 offen sc1
    s_waitcnt vmcnt(0)
    v_and_b32 v3, 0x2020202, v3
    v_cmp_ne_u32 vcc, 0x2020202, v3
    s_nop 0
    s_cmp_eq_u64 vcc, 0
    s_cbranch_scc1 L_polld_22
L_pollf_23:
    s_sleep 2
    s_branch L_poll_21
L_polld_22:
    s_mov_b64 exec, -1
    s_lshl_b32 s58, s56, 14
    s_add_u32 s58, s58, s52
    s_lshl_b32 s59, s56, 10
    s_add_u32 m0, s51, 0
    s_add_u32 s56, s56, 1
    buffer_load_dwordx4 v5, s[28:31], s58 offen lds
    s_add_u32 m0, s51, 1024
    s_add_u32 s48, s58, 8192
    buffer_load_dwordx4 v5, s[28:31], s48 offen lds
    s_add_u32 s48, s53, s59
    s_cmp_eq_u32 s56, 28
    s_cselect_b32 s56, 0, s56
    buffer_load_dwordx4 v[104:107], v1, s[16:19], s48 offen
    s_add_u32 s48, s54, s59
    buffer_load_dwordx4 v[108:111], v1, s[16:19], s48 offen
    s_lshl_b32 s58, s56, 14
    s_add_u32 s58, s58, s52
    s_lshl_b32 s59, s56, 10
    s_add_u32 m0, s51, 2048
    s_add_u32 s56, s56, 1
    buffer_load_dwordx4 v5, s[28:31], s58 offen lds
    s_add_u32 m0, s51, 3072
    s_add_u32 s48, s58, 8192
    buffer_load_dwordx4 v5, s[28:31], s48 offen lds
    s_add_u32 s48, s53, s59
    s_cmp_eq_u32 s56, 28
    s_cselect_b32 s56, 0, s56
    buffer_load_dwordx4 v[112:115], v1, s[16:19], s48 offen
    s_add_u32 s48, s54, s59
    buffer_load_dwordx4 v[116:119], v1, s[16:19], s48 offen
    s_lshl_b32 s58, s56, 14
    s_add_u32 s58, s58, s52
    s_lshl_b32 s59, s56, 10
    s_add_u32 m0, s51, 4096
    s_add_u32 s56, s56, 1
    buffer_load_dwordx4 v5, s[28:31], s58 offen lds
    s_add_u32 m0, s51, 5120
    s_add_u32 s48, s58, 8192
    buffer_load_dwordx4 v5, s[28:31], s48 offen lds
    s_add_u32 s48, s53, s59
    s_cmp_eq_u32 s56, 28
    s_cselect_b32 s56, 0, s56
    buffer_load_dwordx4 v[120:123], v1, s[16:19], s48 offen
    s_add_u32 s48, s54, s59
    buffer_load_dwordx4 v[124:127], v1, s[16:19], s48 offen
    s_lshl_b32 s58, s56, 14
    s_add_u32 s58, s58, s52
    s_lshl_b32 s59, s56, 10
    s_add_u32 m0, s51, 6144
    s_add_u32 s56, s56, 1
    buffer_load_dwordx4 v5, s[28:31], s58 offen lds
    s_add_u32 m0, s51, 7168
    s_add_u32 s48, s58, 8192
    buffer_load_dwordx4 v5, s[28:31], s48 offen lds
    s_add_u32 s48, s53, s59
    s_cmp_eq_u32 s56, 28
    s_cselect_b32 s56, 0, s56
    buffer_load_dwordx4 v[128:131], v1, s[16:19], s48 offen
    s_add_u32 s48, s54, s59
    buffer_load_dwordx4 v[132:135], v1, s[16:19], s48 offen
    s_setprio 0
    s_waitcnt vmcnt(12)
    ds_read_b64_tr_b16 v[144:145], v6 offset:0
    ds_read_b64_tr_b16 v[146:147], v6 offset:1024
    ds_read_b64_tr_b16 v[148:149], v6 offset:512
    ds_read_b64_tr_b16 v[150:151], v6 offset:1536
    s_waitcnt lgkmcnt(0)
    v_mfma_f32_32x32x16_bf16 v[8:23], v[144:147], v[104:107], 0
    s_lshl_b32 s58, s56, 14
    s_add_u32 s58, s58, s52
    s_lshl_b32 s59, s56, 10
    s_add_u32 m0, s51, 0
    s_add_u32 s56, s56, 1
    buffer_load_dwordx4 v5, s[28:31], s58 offen lds
    v_mfma_f32_32x32x16_bf16 v[24:39], v[144:147], v[108:111], 0
    s_add_u32 m0, s51, 1024
    s_add_u32 s48, s58, 8192
    buffer_load_dwordx4 v5, s[28:31], s48 offen lds
    v_mfma_f32_32x32x16_bf16 v[40:55], v[148:151], v[104:107], 0
    s_add_u32 s48, s53, s59
    s_cmp_eq_u32 s56, 28
    s_cselect_b32 s56, 0, s56
    buffer_load_dwordx4 v[136:139], v1, s[16:19], s48 offen
    v_mfma_f32_32x32x16_bf16 v[56:71], v[148:151], v[108:111], 0
    s_add_u32 s48, s54, s59
    buffer_load_dwordx4 v[140:143], v1, s[16:19], s48 offen
    s_waitcnt vmcnt(12)
    ds_read_b64_tr_b16 v[144:145], v6 offset:2048
    ds_read_b64_tr_b16 v[146:147], v6 offset:3072
    ds_read_b64_tr_b16 v[148:149], v6 offset:2560
    ds_read_b64_tr_b16 v[150:151], v6 offset:3584
    s_waitcnt lgkmcnt(0)
    v_mfma_f32_32x32x16_bf16 v[8:23], v[144:147], v[112:115], v[8:23]
    s_lshl_b32 s58, s56, 14
    s_add_u32 s58, s58, s52
    s_lshl_b32 s59, s56, 10
    s_add_u32 m0, s51, 2048
    s_add_u32 s56, s56, 1
    buffer_load_dwordx4 v5, s[28:31], s58 offen lds
    v_mfma_f32_32x32x16_bf16 v[24:39], v[144:147], v[116:119], v[24:39]
    s_add_u32 m0, s51, 3072
    s_add_u32 s48, s58, 8192
    buffer_load_dwordx4 v5, s[28:31], s48 offen lds
    v_mfma_f32_32x32x16_bf16 v[40:55], v[148:151], v[112:115], v[40:55]
    s_add_u32 s48, s53, s59
    s_cmp_eq_u32 s56, 28
    s_cselect_b32 s56, 0, s56
    buffer_load_dwordx4 v[104:107], v1, s[16:19], s48 offen
    v_mfma_f32_32x32x16_bf16 v[56:71], v[148:151], v[116:119], v[56:71]
    s_add_u32 s48, s54, s59
    buffer_load_dwordx4 v[108:111], v1, s[16:19], s48 offen
    s_waitcnt vmcnt(12)
    ds_read_b64_tr_b16 v[144:145], v6 offset:4096
    ds_read_b64_tr_b16 v[146:147], v6 offset:5120
    ds_read_b64_tr_b16 v[148:149], v6 offset:4608
    ds_read_b64_tr_b16 v[150:151], v6 offset:5632
    s_waitcnt lgkmcnt(0)
    v_mfma_f32_32x32x16_bf16 v[8:23], v[144:147], v[120:123], v[8:23]
    s_lshl_b32 s58, s56, 14
    s_add_u32 s58, s58, s52
    s_lshl_b32 s59, s56, 10
    s_add_u32 m0, s51, 4096
    s_add_u32 s56, s56, 1
    buffer_load_dwordx4 v5, s[28:31], s58 offen lds
    v_mfma_f32_32x32x16_bf16 v[24:39], v[144:147], v[124:127], v[24:39]
    s_add_u32 m0, s51, 5120
    s_add_u32 s48, s58, 8192
    buffer_load_dwordx4 v5, s[28:31], s48 offen lds
    v_mfma_f32_32x32x16_bf16 v[40:55], v[148:151], v[120:123], v[40:55]
    s_add_u32 s48, s53, s59
    s_cmp_eq_u32 s56, 28
    s_cselect_b32 s56, 0, s56
    buffer_load_dwordx4 v[112:115], v1, s[16:19], s48 offen
    v_mfma_f32_32x32x16_bf16 v[56:71], v[148:151], v[124:127], v[56:71]
    s_add_u32 s48, s54, s59
    buffer_load_dwordx4 v[116:119], v1, s[16:19], s48 offen
    s_waitcnt vmcnt(12)
    ds_read_b64_tr_b16 v[144:145], v6 offset:6144
    ds_read_b64_tr_b16 v[146:147], v6 offset:7168
    ds_read_b64_tr_b16 v[148:149], v6 offset:6656
    ds_read_b64_tr_b16 v[150:151], v6 offset:7680
    s_waitcnt lgkmcnt(0)
    v_mfma_f32_32x32x16_bf16 v[8:23], v[144:147], v[128:131], v[8:23]
    s_lshl_b32 s58, s56, 14
    s_add_u32 s58, s58, s52
    s_lshl_b32 s59, s56, 10
    s_add_u32 m0, s51, 6144
    s_add_u32 s56, s56, 1
    buffer_load_dwordx4 v5, s[28:31], s58 offen lds
    v_mfma_f32_32x32x16_bf16 v[24:39], v[144:147], v[132:135], v[24:39]
    s_add_u32 m0, s51, 7168
    s_add_u32 s48, s58, 8192
    buffer_load_dwordx4 v5, s[28:31], s48 offen lds
    v_mfma_f32_32x32x16_bf16 v[40:55], v[148:151], v[128:131], v[40:55]
    s_add_u32 s48, s53, s59
    s_cmp_eq_u32 s56, 28
    s_cselect_b32 s56, 0, s56
    buffer_load_dwordx4 v[120:123], v1, s[16:19], s48 offen
    v_mfma_f32_32x32x16_bf16 v[56:71], v[148:151], v[132:135], v[56:71]
    s_add_u32 s48, s54, s59
    buffer_load_dwordx4 v[124:127], v1, s[16:19], s48 offen
    s_waitcnt vmcnt(12)
    ds_read_b64_tr_b16 v[144:145], v6 offset:0
    ds_read_b64_tr_b16 v[146:147], v6 offset:1024
    ds_read_b64_tr_b16 v[148:149], v6 offset:512
    ds_read_b64_tr_b16 v[150:151], v6 offset:1536
    s_waitcnt lgkmcnt(0)
    v_mfma_f32_32x32x16_bf16 v[8:23], v[144:147], v[136:139], v[8:23]
    s_lshl_b32 s58, s56, 14
    s_add_u32 s58, s58, s52
    s_lshl_b32 s59, s56, 10
    s_add_u32 m0, s51, 0
    s_add_u32 s56, s56, 1
    buffer_load_dwordx4 v5, s[28:31], s58 offen lds
    v_mfma_f32_32x32x16_bf16 v[24:39], v[144:147], v[140:143], v[24:39]
    s_add_u32 m0, s51, 1024
    s_add_u32 s48, s58, 8192
    buffer_load_dwordx4 v5, s[28:31], s48 offen lds
    v_mfma_f32_32x32x16_bf16 v[40:55], v[148:151], v[136:139], v[40:55]
    s_add_u32 s48, s53, s59
    s_cmp_eq_u32 s56, 28
    s_cselect_b32 s56, 0, s56
    buffer_load_dwordx4 v[128:131], v1, s[16:19], s48 offen
    v_mfma_f32_32x32x16_bf16 v[56:71], v[148:151], v[140:143], v[56:71]
    s_add_u32 s48, s54, s59
    buffer_load_dwordx4 v[132:135], v1, s[16:19], s48 offen
    s_waitcnt vmcnt(12)
    ds_read_b64_tr_b16 v[144:145], v6 offset:2048
    ds_read_b64_tr_b16 v[146:147], v6 offset:3072
    ds_read_b64_tr_b16 v[148:149], v6 offset:2560
    ds_read_b64_tr_b16 v[150:151], v6 offset:3584
    s_waitcnt lgkmcnt(0)
    v_mfma_f32_32x32x16_bf16 v[8:23], v[144:147], v[104:107], v[8:23]
    s_lshl_b32 s58, s56, 14
    s_add_u32 s58, s58, s52
    s_lshl_b32 s59, s56, 10
    s_add_u32 m0, s51, 2048
    s_add_u32 s56, s56, 1
    buffer_load_dwordx4 v5, s[28:31], s58 offen lds
    v_mfma_f32_32x32x16_bf16 v[24:39], v[144:147], v[108:111], v[24:39]
    s_add_u32 m0, s51, 3072
    s_add_u32 s48, s58, 8192
    buffer_load_dwordx4 v5, s[28:31], s48 offen lds
    v_mfma_f32_32x32x16_bf16 v[40:55], v[148:151], v[104:107], v[40:55]
    s_add_u32 s48, s53, s59
    s_cmp_eq_u32 s56, 28
    s_cselect_b32 s56, 0, s56
    buffer_load_dwordx4 v[136:139], v1, s[16:19], s48 offen
    v_mfma_f32_32x32x16_bf16 v[56:71], v[148:151], v[108:111], v[56:71]
    s_add_u32 s48, s54, s59
    buffer_load_dwordx4 v[140:143], v1, s[16:19], s48 offen
    s_waitcnt vmcnt(12)
    ds_read_b64_tr_b16 v[144:145], v6 offset:4096
    ds_read_b64_tr_b16 v[146:147], v6 offset:5120
    ds_read_b64_tr_b16 v[148:149], v6 offset:4608
    ds_read_b64_tr_b16 v[150:151], v6 offset:5632
    s_waitcnt lgkmcnt(0)
    v_mfma_f32_32x32x16_bf16 v[8:23], v[144:147], v[112:115], v[8:23]
    s_lshl_b32 s58, s56, 14
    s_add_u32 s58, s58, s52
    s_lshl_b32 s59, s56, 10
    s_add_u32 m0, s51, 4096
    s_add_u32 s56, s56, 1
    buffer_load_dwordx4 v5, s[28:31], s58 offen lds
    v_mfma_f32_32x32x16_bf16 v[24:39], v[144:147], v[116:119], v[24:39]
    s_add_u32 m0, s51, 5120
    s_add_u32 s48, s58, 8192
    buffer_load_dwordx4 v5, s[28:31], s48 offen lds
    v_mfma_f32_32x32x16_bf16 v[40:55], v[148:151], v[112:115], v[40:55]
    s_add_u32 s48, s53, s59
    s_cmp_eq_u32 s56, 28
    s_cselect_b32 s56, 0, s56
    buffer_load_dwordx4 v[104:107], v1, s[16:19], s48 offen
    v_mfma_f32_32x32x16_bf16 v[56:71], v[148:151], v[116:119], v[56:71]
    s_add_u32 s48, s54, s59
    buffer_load_dwordx4 v[108:111], v1, s[16:19], s48 offen
    s_waitcnt vmcnt(12)
    ds_read_b64_tr_b16 v[144:145], v6 offset:6144
    ds_read_b64_tr_b16 v[146:147], v6 offset:7168
    ds_read_b64_tr_b16 v[148:149], v6 offset:6656
    ds_read_b64_tr_b16 v[150:151], v6 offset:7680
    s_waitcnt lgkmcnt(0)
    v_mfma_f32_32x32x16_bf16 v[8:23], v[144:147], v[120:123], v[8:23]
    s_lshl_b32 s58, s56, 14
    s_add_u32 s58, s58, s52
    s_lshl_b32 s59, s56, 10
    s_add_u32 m0, s51, 6144
    s_add_u32 s56, s56, 1
    buffer_load_dwordx4 v5, s[28:31], s58 offen lds
    v_mfma_f32_32x32x16_bf16 v[24:39], v[144:147], v[124:127], v[24:39]
    s_add_u32 m0, s51, 7168
    s_add_u32 s48, s58, 8192
    buffer_load_dwordx4 v5, s[28:31], s48 offen lds
    v_mfma_f32_32x32x16_bf16 v[40:55], v[148:151], v[120:123], v[40:55]
    s_add_u32 s48, s53, s59
    s_cmp_eq_u32 s56, 28
    s_cselect_b32 s56, 0, s56
    buffer_load_dwordx4 v[112:115], v1, s[16:19], s48 offen
    v_mfma_f32_32x32x16_bf16 v[56:71], v[148:151], v[124:127], v[56:71]
    s_add_u32 s48, s54, s59
    buffer_load_dwordx4 v[116:119], v1, s[16:19], s48 offen
    s_waitcnt vmcnt(12)
    ds_read_b64_tr_b16 v[144:145], v6 offset:0
    ds_read_b64_tr_b16 v[146:147], v6 offset:1024
    ds_read_b64_tr_b16 v[148:149], v6 offset:512
    ds_read_b64_tr_b16 v[150:151], v6 offset:1536
    s_waitcnt lgkmcnt(0)
    v_mfma_f32_32x32x16_bf16 v[8:23], v[144:147], v[128:131], v[8:23]
    s_lshl_b32 s58, s56, 14
    s_add_u32 s58, s58, s52
    s_lshl_b32 s59, s56, 10
    s_add_u32 m0, s51, 0
    s_add_u32 s56, s56, 1
    buffer_load_dwordx4 v5, s[28:31], s58 offen lds
    v_mfma_f32_32x32x16_bf16 v[24:39], v[144:147], v[132:135], v[24:39]
    s_add_u32 m0, s51, 1024
    s_add_u32 s48, s58, 8192
    buffer_load_dwordx4 v5, s[28:31], s48 offen lds
    v_mfma_f32_32x32x16_bf16 v[40:55], v[148:151], v[128:131], v[40:55]
    s_add_u32 s48, s53, s59
    s_cmp_eq_u32 s56, 28
    s_cselect_b32 s56, 0, s56
    buffer_load_dwordx4 v[120:123], v1, s[16:19], s48 offen
    v_mfma_f32_32x32x16_bf16 v[56:71], v[148:151], v[132:135], v[56:71]
    s_add_u32 s48, s54, s59
    buffer_load_dwordx4 v[124:127], v1, s[16:19], s48 offen
    s_waitcnt vmcnt(12)
    ds_read_b64_tr_b16 v[144:145], v6 offset:2048
    ds_read_b64_tr_b16 v[146:147], v6 offset:3072
    ds_read_b64_tr_b16 v[148:149], v6 offset:2560
    ds_read_b64_tr_b16 v[150:151], v6 offset:3584
    s_waitcnt lgkmcnt(0)
    v_mfma_f32_32x32x16_bf16 v[8:23], v[144:147], v[136:139], v[8:23]
    s_lshl_b32 s58, s56, 14
    s_add_u32 s58, s58, s52
    s_lshl_b32 s59, s56, 10
    s_add_u32 m0, s51, 2048
    s_add_u32 s56, s56, 1
    buffer_load_dwordx4 v5, s[28:31], s58 offen lds
    v_mfma_f32_32x32x16_bf16 v[24:39], v[144:147], v[140:143], v[24:39]
    s_add_u32 m0, s51, 3072
    s_add_u32 s48, s58, 8192
    buffer_load_dwordx4 v5, s[28:31], s48 offen lds
    v_mfma_f32_32x32x16_bf16 v[40:55], v[148:151], v[136:139], v[40:55]
    s_add_u32 s48, s53, s59
    s_cmp_eq_u32 s56, 28
    s_cselect_b32 s56, 0, s56
    buffer_load_dwordx4 v[128:131], v1, s[16:19], s48 offen
    v_mfma_f32_32x32x16_bf16 v[56:71], v[148:151], v[140:143], v[56:71]
    s_add_u32 s48, s54, s59
    buffer_load_dwordx4 v[132:135], v1, s[16:19], s48 offen
    s_waitcnt vmcnt(12)
    ds_read_b64_tr_b16 v[144:145], v6 offset:4096
    ds_read_b64_tr_b16 v[146:147], v6 offset:5120
    ds_read_b64_tr_b16 v[148:149], v6 offset:4608
    ds_read_b64_tr_b16 v[150:151], v6 offset:5632
    s_waitcnt lgkmcnt(0)
    v_mfma_f32_32x32x16_bf16 v[8:23], v[144:147], v[104:107], v[8:23]
    s_lshl_b32 s58, s56, 14
    s_add_u32 s58, s58, s52
    s_lshl_b32 s59, s56, 10
    s_add_u32 m0, s51, 4096
    s_add_u32 s56, s56, 1
    buffer_load_dwordx4 v5, s[28:31], s58 offen lds
    v_mfma_f32_32x32x16_bf16 v[24:39], v[144:147], v[108:111], v[24:39]
    s_add_u32 m0, s51, 5120
    s_add_u32 s48, s58, 8192
    buffer_load_dwordx4 v5, s[28:31], s48 offen lds
    v_mfma_f32_32x32x16_bf16 v[40:55], v[148:151], v[104:107], v[40:55]
    s_add_u32 s48, s53, s59
    s_cmp_eq_u32 s56, 28
    s_cselect_b32 s56, 0, s56
    buffer_load_dwordx4 v[136:139], v1, s[16:19], s48 offen
    v_mfma_f32_32x32x16_bf16 v[56:71], v[148:151], v[108:111], v[56:71]
    s_add_u32 s48, s54, s59
    buffer_load_dwordx4 v[140:143], v1, s[16:19], s48 offen
    s_waitcnt vmcnt(12)
    ds_read_b64_tr_b16 v[144:145], v6 offset:6144
    ds_read_b64_tr_b16 v[146:147], v6 offset:7168
    ds_read_b64_tr_b16 v[148:149], v6 offset:6656
    ds_read_b64_tr_b16 v[150:151], v6 offset:7680
    s_waitcnt lgkmcnt(0)
    v_mfma_f32_32x32x16_bf16 v[8:23], v[144:147], v[112:115], v[8:23]
    s_lshl_b32 s58, s56, 14
    s_add_u32 s58, s58, s52
    s_lshl_b32 s59, s56, 10
    s_add_u32 m0, s51, 6144
    s_add_u32 s56, s56, 1
    buffer_load_dwordx4 v5, s[28:31], s58 offen lds
    v_mfma_f32_32x32x16_bf16 v[24:39], v[144:147], v[116:119], v[24:39]
    s_add_u32 m0, s51, 7168
    s_add_u32 s48, s58, 8192
    buffer_load_dwordx4 v5, s[28:31], s48 offen lds
    v_mfma_f32_32x32x16_bf16 v[40:55], v[148:151], v[112:115], v[40:55]
    s_add_u32 s48, s53, s59
    s_cmp_eq_u32 s56, 28
    s_cselect_b32 s56, 0, s56
    buffer_load_dwordx4 v[104:107], v1, s[16:19], s48 offen
    v_mfma_f32_32x32x16_bf16 v[56:71], v[148:151], v[116:119], v[56:71]
    s_add_u32 s48, s54, s59
    buffer_load_dwordx4 v[108:111], v1, s[16:19], s48 offen
    s_waitcnt vmcnt(12)
    ds_read_b64_tr_b16 v[144:145], v6 offset:0
    ds_read_b64_tr_b16 v[146:147], v6 offset:1024
    ds_read_b64_tr_b16 v[148:149], v6 offset:512
    ds_read_b64_tr_b16 v[150:151], v6 offset:1536
    s_waitcnt lgkmcnt(0)
    v_mfma_f32_32x32x16_bf16 v[8:23], v[144:147], v[120:123], v[8:23]
    s_lshl_b32 s58, s56, 14
    s_add_u32 s58, s58, s52
    s_lshl_b32 s59, s56, 10
    s_add_u32 m0, s51, 0
    s_add_u32 s56, s56, 1
    buffer_load_dwordx4 v5, s[28:31], s58 offen lds
    v_mfma_f32_32x32x16_bf16 v[24:39], v[144:147], v[124:127], v[24:39]
    s_add_u32 m0, s51, 1024
    s_add_u32 s48, s58, 8192
    buffer_load_dwordx4 v5, s[28:31], s48 offen lds
    v_mfma_f32_32x32x16_bf16 v[40:55], v[148:151], v[120:123], v[40:55]
    s_add_u32 s48, s53, s59
    s_cmp_eq_u32 s56, 28
    s_cselect_b32 s56, 0, s56
    buffer_load_dwordx4 v[112:115], v1, s[16:19], s48 offen
    v_mfma_f32_32x32x16_bf16 v[56:71], v[148:151], v[124:127], v[56:71]
    s_add_u32 s48, s54, s59
    buffer_load_dwordx4 v[116:119], v1, s[16:19], s48 offen
    s_waitcnt vmcnt(12)
    ds_read_b64_tr_b16 v[144:145], v6 offset:2048
    ds_read_b64_tr_b16 v[146:147], v6 offset:3072
    ds_read_b64_tr_b16 v[148:149], v6 offset:2560
    ds_read_b64_tr_b16 v[150:151], v6 offset:3584
    s_waitcnt lgkmcnt(0)
    v_mfma_f32_32x32x16_bf16 v[8:23], v[144:147], v[128:131], v[8:23]
    s_lshl_b32 s58, s56, 14
    s_add_u32 s58, s58, s52
    s_lshl_b32 s59, s56, 10
    s_add_u32 m0, s51, 2048
    s_add_u32 s56, s56, 1
    buffer_load_dwordx4 v5, s[28:31], s58 offen lds
    v_mfma_f32_32x32x16_bf16 v[24:39], v[144:147], v[132:135], v[24:39]
    s_add_u32 m0, s51, 3072
    s_add_u32 s48, s58, 8192
    buffer_load_dwordx4 v5, s[28:31], s48 offen lds
    v_mfma_f32_32x32x16_bf16 v[40:55], v[148:151], v[128:131], v[40:55]
    s_add_u32 s48, s53, s59
    s_cmp_eq_u32 s56, 28
    s_cselect_b32 s56, 0, s56
    buffer_load_dwordx4 v[120:123], v1, s[16:19], s48 offen
    v_mfma_f32_32x32x16_bf16 v[56:71], v[148:151], v[132:135], v[56:71]
    s_add_u32 s48, s54, s59
    buffer_load_dwordx4 v[124:127], v1, s[16:19], s48 offen
    s_waitcnt vmcnt(12)
    ds_read_b64_tr_b16 v[144:145], v6 offset:4096
    ds_read_b64_tr_b16 v[146:147], v6 offset:5120
    ds_read_b64_tr_b16 v[148:149], v6 offset:4608
    ds_read_b64_tr_b16 v[150:151], v6 offset:5632
    s_waitcnt lgkmcnt(0)
    v_mfma_f32_32x32x16_bf16 v[8:23], v[144:147], v[136:139], v[8:23]
    s_lshl_b32 s58, s56, 14
    s_add_u32 s58, s58, s52
    s_lshl_b32 s59, s56, 10
    s_add_u32 m0, s51, 4096
    s_add_u32 s56, s56, 1
    buffer_load_dwordx4 v5, s[28:31], s58 offen lds
    v_mfma_f32_32x32x16_bf16 v[24:39], v[144:147], v[140:143], v[24:39]
    s_add_u32 m0, s51, 5120
    s_add_u32 s48, s58, 8192
    buffer_load_dwordx4 v5, s[28:31], s48 offen lds
    v_mfma_f32_32x32x16_bf16 v[40:55], v[148:151], v[136:139], v[40:55]
    s_add_u32 s48, s53, s59
    s_cmp_eq_u32 s56, 28
    s_cselect_b32 s56, 0, s56
    buffer_load_dwordx4 v[128:131], v1, s[16:19], s48 offen
    v_mfma_f32_32x32x16_bf16 v[56:71], v[148:151], v[140:143], v[56:71]
    s_add_u32 s48, s54, s59
    buffer_load_dwordx4 v[132:135], v1, s[16:19], s48 offen
    s_waitcnt vmcnt(12)
    ds_read_b64_tr_b16 v[144:145], v6 offset:6144
    ds_read_b64_tr_b16 v[146:147], v6 offset:7168
    ds_read_b64_tr_b16 v[148:149], v6 offset:6656
    ds_read_b64_tr_b16 v[150:151], v6 offset:7680
    s_waitcnt lgkmcnt(0)
    v_mfma_f32_32x32x16_bf16 v[8:23], v[144:147], v[104:107], v[8:23]
    s_lshl_b32 s58, s56, 14
    s_add_u32 s58, s58, s52
    s_lshl_b32 s59, s56, 10
    s_add_u32 m0, s51, 6144
    s_add_u32 s56, s56, 1
    buffer_load_dwordx4 v5, s[28:31], s58 offen lds
    v_mfma_f32_32x32x16_bf16 v[24:39], v[144:147], v[108:111], v[24:39]
    s_add_u32 m0, s51, 7168
    s_add_u32 s48, s58, 8192
    buffer_load_dwordx4 v5, s[28:31], s48 offen lds
    v_mfma_f32_32x32x16_bf16 v[40:55], v[148:151], v[104:107], v[40:55]
    s_add_u32 s48, s53, s59
    s_cmp_eq_u32 s56, 28
    s_cselect_b32 s56, 0, s56
    buffer_load_dwordx4 v[136:139], v1, s[16:19], s48 offen
    v_mfma_f32_32x32x16_bf16 v[56:71], v[148:151], v[108:111], v[56:71]
    s_add_u32 s48, s54, s59
    buffer_load_dwordx4 v[140:143], v1, s[16:19], s48 offen
    s_waitcnt vmcnt(12)
    ds_read_b64_tr_b16 v[144:145], v6 offset:0
    ds_read_b64_tr_b16 v[146:147], v6 offset:1024
    ds_read_b64_tr_b16 v[148:149], v6 offset:512
    ds_read_b64_tr_b16 v[150:151], v6 offset:1536
    s_waitcnt lgkmcnt(0)
    v_mfma_f32_32x32x16_bf16 v[8:23], v[144:147], v[112:115], v[8:23]
    s_lshl_b32 s58, s56, 14
    s_add_u32 s58, s58, s52
    s_lshl_b32 s59, s56, 10
    s_add_u32 m0, s51, 0
    s_add_u32 s56, s56, 1
    buffer_load_dwordx4 v5, s[28:31], s58 offen lds
    v_mfma_f32_32x32x16_bf16 v[24:39], v[144:147], v[116:119], v[24:39]
    s_add_u32 m0, s51, 1024
    s_add_u32 s48, s58, 8192
    buffer_load_dwordx4 v5, s[28:31], s48 offen lds
    v_mfma_f32_32x32x16_bf16 v[40:55], v[148:151], v[112:115], v[40:55]
    s_add_u32 s48, s53, s59
    s_cmp_eq_u32 s56, 28
    s_cselect_b32 s56, 0, s56
    buffer_load_dwordx4 v[104:107], v1, s[16:19], s48 offen
    v_mfma_f32_32x32x16_bf16 v[56:71], v[148:151], v[116:119], v[56:71]
    s_add_u32 s48, s54, s59
    buffer_load_dwordx4 v[108:111], v1, s[16:19], s48 offen
    s_waitcnt vmcnt(12)
    ds_read_b64_tr_b16 v[144:145], v6 offset:2048
    ds_read_b64_tr_b16 v[146:147], v6 offset:3072
    ds_read_b64_tr_b16 v[148:149], v6 offset:2560
    ds_read_b64_tr_b16 v[150:151], v6 offset:3584
    s_waitcnt lgkmcnt(0)
    v_mfma_f32_32x32x16_bf16 v[8:23], v[144:147], v[120:123], v[8:23]
    s_lshl_b32 s58, s56, 14
    s_add_u32 s58, s58, s52
    s_lshl_b32 s59, s56, 10
    s_add_u32 m0, s51, 2048
    s_add_u32 s56, s56, 1
    buffer_load_dwordx4 v5, s[28:31], s58 offen lds
    v_mfma_f32_32x32x16_bf16 v[24:39], v[144:147], v[124:127], v[24:39]
    s_add_u32 m0, s51, 3072
    s_add_u32 s48, s58, 8192
    buffer_load_dwordx4 v5, s[28:31], s48 offen lds
    v_mfma_f32_32x32x16_bf16 v[40:55], v[148:151], v[120:123], v[40:55]
    s_add_u32 s48, s53, s59
    s_cmp_eq_u32 s56, 28
    s_cselect_b32 s56, 0, s56
    buffer_load_dwordx4 v[112:115], v1, s[16:19], s48 offen
    v_mfma_f32_32x32x16_bf16 v[56:71], v[148:151], v[124:127], v[56:71]
    s_add_u32 s48, s54, s59
    buffer_load_dwordx4 v[116:119], v1, s[16:19], s48 offen
    s_waitcnt vmcnt(12)
    ds_read_b64_tr_b16 v[144:145], v6 offset:4096
    ds_read_b64_tr_b16 v[146:147], v6 offset:5120
    ds_read_b64_tr_b16 v[148:149], v6 offset:4608
    ds_read_b64_tr_b16 v[150:151], v6 offset:5632
    s_waitcnt lgkmcnt(0)
    v_mfma_f32_32x32x16_bf16 v[8:23], v[144:147], v[128:131], v[8:23]
    s_lshl_b32 s58, s56, 14
    s_add_u32 s58, s58, s52
    s_lshl_b32 s59, s56, 10
    s_add_u32 m0, s51, 4096
    s_add_u32 s56, s56, 1
    buffer_load_dwordx4 v5, s[28:31], s58 offen lds
    v_mfma_f32_32x32x16_bf16 v[24:39], v[144:147], v[132:135], v[24:39]
    s_add_u32 m0, s51, 5120
    s_add_u32 s48, s58, 8192
    buffer_load_dwordx4 v5, s[28:31], s48 offen lds
    v_mfma_f32_32x32x16_bf16 v[40:55], v[148:151], v[128:131], v[40:55]
    s_add_u32 s48, s53, s59
    s_cmp_eq_u32 s56, 28
    s_cselect_b32 s56, 0, s56
    buffer_load_dwordx4 v[120:123], v1, s[16:19], s48 offen
    v_mfma_f32_32x32x16_bf16 v[56:71], v[148:151], v[132:135], v[56:71]
    s_add_u32 s48, s54, s59
    buffer_load_dwordx4 v[124:127], v1, s[16:19], s48 offen
    s_waitcnt vmcnt(12)
    ds_read_b64_tr_b16 v[144:145], v6 offset:6144
    ds_read_b64_tr_b16 v[146:147], v6 offset:7168
    ds_read_b64_tr_b16 v[148:149], v6 offset:6656
    ds_read_b64_tr_b16 v[150:151], v6 offset:7680
    s_waitcnt lgkmcnt(0)
    v_mfma_f32_32x32x16_bf16 v[8:23], v[144:147], v[136:139], v[8:23]
    s_lshl_b32 s58, s56, 14
    s_add_u32 s58, s58, s52
    s_lshl_b32 s59, s56, 10
    s_add_u32 m0, s51, 6144
    s_add_u32 s56, s56, 1
    buffer_load_dwordx4 v5, s[28:31], s58 offen lds
    v_mfma_f32_32x32x16_bf16 v[24:39], v[144:147], v[140:143], v[24:39]
    s_add_u32 m0, s51, 7168
    s_add_u32 s48, s58, 8192
    buffer_load_dwordx4 v5, s[28:31], s48 offen lds
    v_mfma_f32_32x32x16_bf16 v[40:55], v[148:151], v[136:139], v[40:55]
    s_add_u32 s48, s53, s59
    s_cmp_eq_u32 s56, 28
    s_cselect_b32 s56, 0, s56
    buffer_load_dwordx4 v[128:131], v1, s[16:19], s48 offen
    v_mfma_f32_32x32x16_bf16 v[56:71], v[148:151], v[140:143], v[56:71]
    s_add_u32 s48, s54, s59
    buffer_load_dwordx4 v[132:135], v1, s[16:19], s48 offen
    s_waitcnt vmcnt(12)
    ds_read_b64_tr_b16 v[144:145], v6 offset:0
    ds_read_b64_tr_b16 v[146:147], v6 offset:1024
    ds_read_b64_tr_b16 v[148:149], v6 offset:512
    ds_read_b64_tr_b16 v[150:151], v6 offset:1536
    s_waitcnt lgkmcnt(0)
    v_mfma_f32_32x32x16_bf16 v[8:23], v[144:147], v[104:107], v[8:23]
    s_lshl_b32 s58, s56, 14
    s_add_u32 s58, s58, s52
    s_lshl_b32 s59, s56, 10
    s_add_u32 m0, s51, 0
    s_add_u32 s56, s56, 1
    buffer_load_dwordx4 v5, s[28:31], s58 offen lds
    v_mfma_f32_32x32x16_bf16 v[24:39], v[144:147], v[108:111], v[24:39]
    s_add_u32 m0, s51, 1024
    s_add_u32 s48, s58, 8192
    buffer_load_dwordx4 v5, s[28:31], s48 offen lds
    v_mfma_f32_32x32x16_bf16 v[40:55], v[148:151], v[104:107], v[40:55]
    s_add_u32 s48, s53, s59
    s_cmp_eq_u32 s56, 28
    s_cselect_b32 s56, 0, s56
    buffer_load_dwordx4 v[136:139], v1, s[16:19], s48 offen
    v_mfma_f32_32x32x16_bf16 v[56:71], v[148:151], v[108:111], v[56:71]
    s_add_u32 s48, s54, s59
    buffer_load_dwordx4 v[140:143], v1, s[16:19], s48 offen
    s_waitcnt vmcnt(12)
    ds_read_b64_tr_b16 v[144:145], v6 offset:2048
    ds_read_b64_tr_b16 v[146:147], v6 offset:3072
    ds_read_b64_tr_b16 v[148:149], v6 offset:2560
    ds_read_b64_tr_b16 v[150:151], v6 offset:3584
    s_waitcnt lgkmcnt(0)
    v_mfma_f32_32x32x16_bf16 v[8:23], v[144:147], v[112:115], v[8:23]
    s_lshl_b32 s58, s56, 14
    s_add_u32 s58, s58, s52
    s_lshl_b32 s59, s56, 10
    s_add_u32 m0, s51, 2048
    s_add_u32 s56, s56, 1
    buffer_load_dwordx4 v5, s[28:31], s58 offen lds
    v_mfma_f32_32x32x16_bf16 v[24:39], v[144:147], v[116:119], v[24:39]
    s_add_u32 m0, s51, 3072
    s_add_u32 s48, s58, 8192
    buffer_load_dwordx4 v5, s[28:31], s48 offen lds
    v_mfma_f32_32x32x16_bf16 v[40:55], v[148:151], v[112:115], v[40:55]
    s_add_u32 s48, s53, s59
    s_cmp_eq_u32 s56, 28
    s_cselect_b32 s56, 0, s56
    buffer_load_dwordx4 v[104:107], v1, s[16:19], s48 offen
    v_mfma_f32_32x32x16_bf16 v[56:71], v[148:151], v[116:119], v[56:71]
    s_add_u32 s48, s54, s59
    buffer_load_dwordx4 v[108:111], v1, s[16:19], s48 offen
    s_waitcnt vmcnt(12)
    ds_read_b64_tr_b16 v[144:145], v6 offset:4096
    ds_read_b64_tr_b16 v[146:147], v6 offset:5120
    ds_read_b64_tr_b16 v[148:149], v6 offset:4608
    ds_read_b64_tr_b16 v[150:151], v6 offset:5632
    s_waitcnt lgkmcnt(0)
    v_mfma_f32_32x32x16_bf16 v[8:23], v[144:147], v[120:123], v[8:23]
    s_lshl_b32 s58, s56, 14
    s_add_u32 s58, s58, s52
    s_lshl_b32 s59, s56, 10
    s_add_u32 m0, s51, 4096
    s_add_u32 s56, s56, 1
    buffer_load_dwordx4 v5, s[28:31], s58 offen lds
    v_mfma_f32_32x32x16_bf16 v[24:39], v[144:147], v[124:127], v[24:39]
    s_add_u32 m0, s51, 5120
    s_add_u32 s48, s58, 8192
    buffer_load_dwordx4 v5, s[28:31], s48 offen lds
    v_mfma_f32_32x32x16_bf16 v[40:55], v[148:151], v[120:123], v[40:55]
    s_add_u32 s48, s53, s59
    s_cmp_eq_u32 s56, 28
    s_cselect_b32 s56, 0, s56
    buffer_load_dwordx4 v[112:115], v1, s[16:19], s48 offen
    v_mfma_f32_32x32x16_bf16 v[56:71], v[148:151], v[124:127], v[56:71]
    s_add_u32 s48, s54, s59
    buffer_load_dwordx4 v[116:119], v1, s[16:19], s48 offen
    s_waitcnt vmcnt(12)
    ds_read_b64_tr_b16 v[144:145], v6 offset:6144
    ds_read_b64_tr_b16 v[146:147], v6 offset:7168
    ds_read_b64_tr_b16 v[148:149], v6 offset:6656
    ds_read_b64_tr_b16 v[150:151], v6 offset:7680
    s_waitcnt lgkmcnt(0)
    v_mfma_f32_32x32x16_bf16 v[8:23], v[144:147], v[128:131], v[8:23]
    s_lshl_b32 s58, s56, 14
    s_add_u32 s58, s58, s52
    s_lshl_b32 s59, s56, 10
    s_add_u32 m0, s51, 6144
    s_add_u32 s56, s56, 1
    buffer_load_dwordx4 v5, s[28:31], s58 offen lds
    v_mfma_f32_32x32x16_bf16 v[24:39], v[144:147], v[132:135], v[24:39]
    s_add_u32 m0, s51, 7168
    s_add_u32 s48, s58, 8192
    buffer_load_dwordx4 v5, s[28:31], s48 offen lds
    v_mfma_f32_32x32x16_bf16 v[40:55], v[148:151], v[128:131], v[40:55]
    s_add_u32 s48, s53, s59
    s_cmp_eq_u32 s56, 28
    s_cselect_b32 s56, 0, s56
    buffer_load_dwordx4 v[120:123], v1, s[16:19], s48 offen
    v_mfma_f32_32x32x16_bf16 v[56:71], v[148:151], v[132:135], v[56:71]
    s_add_u32 s48, s54, s59
    buffer_load_dwordx4 v[124:127], v1, s[16:19], s48 offen
    s_waitcnt vmcnt(12)
    ds_read_b64_tr_b16 v[144:145], v6 offset:0
    ds_read_b64_tr_b16 v[146:147], v6 offset:1024
    ds_read_b64_tr_b16 v[148:149], v6 offset:512
    ds_read_b64_tr_b16 v[150:151], v6 offset:1536
    s_waitcnt lgkmcnt(0)
    v_mfma_f32_32x32x16_bf16 v[8:23], v[144:147], v[136:139], v[8:23]
    v_mfma_f32_32x32x16_bf16 v[24:39], v[144:147], v[140:143], v[24:39]
    v_mfma_f32_32x32x16_bf16 v[40:55], v[148:151], v[136:139], v[40:55]
    v_mfma_f32_32x32x16_bf16 v[56:71], v[148:151], v[140:143], v[56:71]
    s_waitcnt vmcnt(8)
    ds_read_b64_tr_b16 v[144:145], v6 offset:2048
    ds_read_b64_tr_b16 v[146:147], v6 offset:3072
    ds_read_b64_tr_b16 v[148:149], v6 offset:2560
    ds_read_b64_tr_b16 v[150:151], v6 offset:3584
    s_waitcnt lgkmcnt(0)
    v_mfma_f32_32x32x16_bf16 v[8:23], v[144:147], v[104:107], v[8:23]
    v_mfma_f32_32x32x16_bf16 v[24:39], v[144:147], v[108:111], v[24:39]
    v_mfma_f32_32x32x16_bf16 v[40:55], v[148:151], v[104:107], v[40:55]
    v_mfma_f32_32x32x16_bf16 v[56:71], v[148:151], v[108:111], v[56:71]
    s_waitcnt vmcnt(4)
    ds_read_b64_tr_b16 v[144:145], v6 offset:4096
    ds_read_b64_tr_b16 v[146:147], v6 offset:5120
    ds_read_b64_tr_b16 v[148:149], v6 offset:4608
    ds_read_b64_tr_b16 v[150:151], v6 offset:5632
    s_waitcnt lgkmcnt(0)
    v_mfma_f32_32x32x16_bf16 v[8:23], v[144:147], v[112:115], v[8:23]
    v_mfma_f32_32x32x16_bf16 v[24:39], v[144:147], v[116:119], v[24:39]
    v_mfma_f32_32x32x16_bf16 v[40:55], v[148:151], v[112:115], v[40:55]
    v_mfma_f32_32x32x16_bf16 v[56:71], v[148:151], v[116:119], v[56:71]
    s_waitcnt vmcnt(0)
    ds_read_b64_tr_b16 v[144:145], v6 offset:6144
    ds_read_b64_tr_b16 v[146:147], v6 offset:7168
    ds_read_b64_tr_b16 v[148:149], v6 offset:6656
    ds_read_b64_tr_b16 v[150:151], v6 offset:7680
    s_waitcnt lgkmcnt(0)
    v_mfma_f32_32x32x16_bf16 v[8:23], v[144:147], v[120:123], v[8:23]
    v_mfma_f32_32x32x16_bf16 v[24:39], v[144:147], v[124:127], v[24:39]
    v_mfma_f32_32x32x16_bf16 v[40:55], v[148:151], v[120:123], v[40:55]
    v_mfma_f32_32x32x16_bf16 v[56:71], v[148:151], v[124:127], v[56:71]
    s_setprio 3
    v_and_b32 v2, 31, v0
    v_lshlrev_b32 v2, 2, v2
    s_lshl_b32 s48, s46, 8
    s_add_u32 s48, s48, 0xe00000
    buffer_load_dword v3, v2, s[16:19], s48 offen
    buffer_load_dword v4, v2, s[16:19], s48 offen offset:128
    s_add_u32 m0, s51, 0
    s_add_u32 s48, s57, 65536
    buffer_load_dwordx4 v5, s[32:35], s48 offen lds
    s_add_u32 m0, s51, 1024
    s_add_u32 s48, s57, 73728
    buffer_load_dwordx4 v5, s[32:35], s48 offen lds
    s_add_u32 m0, s51, 2048
    s_add_u32 s48, s57, 81920
    buffer_load_dwordx4 v5, s[32:35], s48 offen lds
    s_add_u32 m0, s51, 3072
    s_add_u32 s48, s57, 90112
    buffer_load_dwordx4 v5, s[32:35], s48 offen lds
    s_add_u32 m0, s51, 4096
    s_add_u32 s48, s57, 98304
    buffer_load_dwordx4 v5, s[32:35], s48 offen lds
    s_add_u32 m0, s51, 5120
    s_add_u32 s48, s57, 106496
    buffer_load_dwordx4 v5, s[32:35], s48 offen lds
    s_add_u32 m0, s51, 6144
    s_add_u32 s48, s57, 114688
    buffer_load_dwordx4 v5, s[32:35], s48 offen lds
    s_add_u32 m0, s51, 7168
    s_add_u32 s48, s57, 122880
    buffer_load_dwordx4 v5, s[32:35], s48 offen lds
    s_waitcnt vmcnt(8)
    v_sub_f32 v3, 1.0, v3
    v_sub_f32 v4, 1.0, v4
    v_mul_f32 v8, v8, v3
    v_mul_f32 v9, v9, v3
    v_mul_f32 v10, v10, v3
    v_mul_f32 v11, v11, v3
    v_mul_f32 v12, v12, v3
    v_mul_f32 v13, v13, v3
    v_mul_f32 v14, v14, v3
    v_mul_f32 v15, v15, v3
    v_mul_f32 v16, v16, v3
    v_mul_f32 v17, v17, v3
    v_mul_f32 v18, v18, v3
    v_mul_f32 v19, v19, v3
    v_mul_f32 v20, v20, v3
    v_mul_f32 v21, v21, v3
    v_mul_f32 v22, v22, v3
    v_mul_f32 v23, v23, v3
    v_mul_f32 v24, v24, v4
    v_mul_f32 v25, v25, v4
    v_mul_f32 v26, v26, v4
    v_mul_f32 v27, v27, v4
    v_mul_f32 v28, v28, v4
    v_mul_f32 v29, v29, v4
    v_mul_f32 v30, v30, v4
    v_mul_f32 v31, v31, v4
    v_mul_f32 v32, v32, v4
    v_mul_f32 v33, v33, v4
    v_mul_f32 v34, v34, v4
    v_mul_f32 v35, v35, v4
    v_mul_f32 v36, v36, v4
    v_mul_f32 v37, v37, v4
    v_mul_f32 v38, v38, v4
    v_mul_f32 v39, v39, v4
    v_mul_f32 v40, v40, v3
    v_mul_f32 v41, v41, v3
    v_mul_f32 v42, v42, v3
    v_mul_f32 v43, v43, v3
    v_mul_f32 v44, v44, v3
    v_mul_f32 v45, v45, v3
    v_mul_f32 v46, v46, v3
    v_mul_f32 v47, v47, v3
    v_mul_f32 v48, v48, v3
    v_mul_f32 v49, v49, v3
    v_mul_f32 v50, v50, v3
    v_mul_f32 v51, v51, v3
    v_mul_f32 v52, v52, v3
    v_mul_f32 v53, v53, v3
    v_mul_f32 v54, v54, v3
    v_mul_f32 v55, v55, v3
    v_mul_f32 v56, v56, v4
    v_mul_f32 v57, v57, v4
    v_mul_f32 v58, v58, v4
    v_mul_f32 v59, v59, v4
    v_mul_f32 v60, v60, v4
    v_mul_f32 v61, v61, v4
    v_mul_f32 v62, v62, v4
    v_mul_f32 v63, v63, v4
    v_mul_f32 v64, v64, v4
    v_mul_f32 v65, v65, v4
    v_mul_f32 v66, v66, v4
    v_mul_f32 v67, v67, v4
    v_mul_f32 v68, v68, v4
    v_mul_f32 v69, v69, v4
    v_mul_f32 v70, v70, v4
    v_mul_f32 v71, v71, v4
    v_lshlrev_b32 v2, 2, v0
    buffer_load_dword v3, v2, s[24:27], 0 offen
    s_mov_b32 s48, 0
    s_waitcnt vmcnt(0)
    ds_read_b64_tr_b16 v[104:105], v6 offset:0
    ds_read_b64_tr_b16 v[106:107], v6 offset:1024
    ds_read_b64_tr_b16 v[108:109], v6 offset:512
    ds_read_b64_tr_b16 v[110:111], v6 offset:1536
    ds_read_b64_tr_b16 v[112:113], v6 offset:2048
    ds_read_b64_tr_b16 v[114:115], v6 offset:3072
    ds_read_b64_tr_b16 v[116:117], v6 offset:2560
    ds_read_b64_tr_b16 v[118:119], v6 offset:3584
    ds_read_b64_tr_b16 v[120:121], v6 offset:4096
    ds_read_b64_tr_b16 v[122:123], v6 offset:5120
    ds_read_b64_tr_b16 v[124:125], v6 offset:4608
    ds_read_b64_tr_b16 v[126:127], v6 offset:5632
    ds_read_b64_tr_b16 v[128:129], v6 offset:6144
    ds_read_b64_tr_b16 v[130:131], v6 offset:7168
    ds_read_b64_tr_b16 v[132:133], v6 offset:6656
    ds_read_b64_tr_b16 v[134:135], v6 offset:7680
L_live:
    v_and_b32 v3, 0x02020202, v3
    v_cmp_ne_u32 vcc, 0x02020202, v3
    s_add_u32 s48, s48, 1
    s_cmp_eq_u64 vcc, 0
    s_cbranch_scc1 L_lived
    s_cmp_ge_u32 s48, 262144
    s_cbranch_scc1 L_lived
    s_sleep 8
    buffer_load_dword v3, v2, s[24:27], 0 offen sc1
    s_waitcnt vmcnt(0)
    s_branch L_live
L_lived:
    s_lshl_b32 s54, s46, 16
    s_lshl_b32 s48, s50, 13
    s_add_u32 s54, s54, s48
    s_add_u32 s54, s54, 0x1000000
    s_add_u32 s53, s54, 0x8000
    v_add_u32 v2, s51, v1
    s_mov_b32 s55, 0xff
    s_mov_b32 s56, 0
    s_waitcnt lgkmcnt(0)
L_probe:
    buffer_load_dword v3, v1, s[16:19], s53 offen sc1
    s_waitcnt vmcnt(0)
    v_cmp_eq_u32 vcc, -1, v3
    s_add_u32 s56, s56, 1
    s_cmp_eq_u64 vcc, 0
    s_cbranch_scc1 L_probed
    s_cmp_ge_u32 s56, 262144
    s_cbranch_scc1 L_probed
    s_sleep 4
    s_branch L_probe
L_probed:
    s_mov_b32 s56, 0
L_oround:
    s_bitcmp0_b32 s55, 0
    s_cbranch_scc1 L_oi_24
    buffer_load_dwordx4 v[136:139], v1, s[16:19], s54 offen offset:0 sc1
    buffer_load_dwordx4 v[140:143], v1, s[16:19], s53 offen offset:0 sc1
L_oi_24:
    s_bitcmp0_b32 s55, 1
    s_cbranch_scc1 L_oi_25
    buffer_load_dwordx4 v[144:147], v1, s[16:19], s54 offen offset:1024 sc1
    buffer_load_dwordx4 v[148:151], v1, s[16:19], s53 offen offset:1024 sc1
L_oi_25:
    s_bitcmp0_b32 s55, 2
    s_cbranch_scc1 L_oi_26
    buffer_load_dwordx4 v[152:155], v1, s[16:19], s54 offen offset:2048 sc1
    buffer_load_dwordx4 v[156:159], v1, s[16:19], s53 offen offset:2048 sc1
L_oi_26:
    s_bitcmp0_b32 s55, 3
    s_cbranch_scc1 L_oi_27
    buffer_load_dwordx4 v[160:163], v1, s[16:19], s54 offen offset:3072 sc1
    buffer_load_dwordx4 v[164:167], v1, s[16:19], s53 offen offset:3072 sc1
L_oi_27:
    s_bitcmp0_b32 s55, 4
    s_cbranch_scc1 L_oi_28
    s_add_u32 m0, s51, 0
    s_add_u32 s48, s54, 4096
    buffer_load_dwordx4 v1, s[16:19], s48 offen sc1 lds
    s_add_u32 m0, s51, 1024
    s_add_u32 s48, s53, 4096
    buffer_load_dwordx4 v1, s[16:19], s48 offen sc1 lds
L_oi_28:
    s_bitcmp0_b32 s55, 5
    s_cbranch_scc1 L_oi_29
    s_add_u32 m0, s51, 2048
    s_add_u32 s48, s54, 5120
    buffer_load_dwordx4 v1, s[16:19], s48 offen sc1 lds
    s_add_u32 m0, s51, 3072
    s_add_u32 s48, s53, 5120
    buffer_load_dwordx4 v1, s[16:19], s48 offen sc1 lds
L_oi_29:
    s_bitcmp0_b32 s55, 6
    s_cbranch_scc1 L_oi_30
    s_add_u32 m0, s51, 4096
    s_add_u32 s48, s54, 6144
    buffer_load_dwordx4 v1, s[16:19], s48 offen sc1 lds
    s_add_u32 m0, s51, 5120
    s_add_u32 s48, s53, 6144
    buffer_load_dwordx4 v1, s[16:19], s48 offen sc1 lds
L_oi_30:
    s_bitcmp0_b32 s55, 7
    s_cbranch_scc1 L_oi_31
    s_add_u32 m0, s51, 6144
    s_add_u32 s48, s54, 7168
    buffer_load_dwordx4 v1, s[16:19], s48 offen sc1 lds
    s_add_u32 m0, s51, 7168
    s_add_u32 s48, s53, 7168
    buffer_load_dwordx4 v1, s[16:19], s48 offen sc1 lds
L_oi_31:
    s_waitcnt vmcnt(0)
    s_bitcmp0_b32 s55, 0
    s_cbranch_scc1 L_oc_33
    v_max3_u32 v3, v136, v137, v138
    v_max3_u32 v4, v139, v140, v141
    v_max3_u32 v3, v3, v142, v143
    v_max_u32 v3, v3, v4
    v_cmp_eq_u32 vcc, -1, v3
    s_nop 0
    s_cmp_lg_u64 vcc, 0
    s_cbranch_scc1 L_oc_33
    s_bitset0_b32 s55, 0
    v_mfma_f32_32x32x16_bf16 v[8:23], v[72:75], v[136:139], v[8:23]
    v_mfma_f32_32x32x16_bf16 v[24:39], v[72:75], v[140:143], v[24:39]
    v_mfma_f32_32x32x16_bf16 v[40:55], v[76:79], v[136:139], v[40:55]
    v_mfma_f32_32x32x16_bf16 v[56:71], v[76:79], v[140:143], v[56:71]
L_oc_33:
    s_bitcmp0_b32 s55, 1
    s_cbranch_scc1 L_oc_34
    v_max3_u32 v3, v144, v145, v146
    v_max3_u32 v4, v147, v148, v149
    v_max3_u32 v3, v3, v150, v151
    v_max_u32 v3, v3, v4
    v_cmp_eq_u32 vcc, -1, v3
    s_nop 0
    s_cmp_lg_u64 vcc, 0
    s_cbranch_scc1 L_oc_34
    s_bitset0_b32 s55, 1
    v_mfma_f32_32x32x16_bf16 v[8:23], v[80:83], v[144:147], v[8:23]
    v_mfma_f32_32x32x16_bf16 v[24:39], v[80:83], v[148:151], v[24:39]
    v_mfma_f32_32x32x16_bf16 v[40:55], v[84:87], v[144:147], v[40:55]
    v_mfma_f32_32x32x16_bf16 v[56:71], v[84:87], v[148:151], v[56:71]
L_oc_34:
    s_bitcmp0_b32 s55, 2
    s_cbranch_scc1 L_oc_35
    v_max3_u32 v3, v152, v153, v154
    v_max3_u32 v4, v155, v156, v157
    v_max3_u32 v3, v3, v158, v159
    v_max_u32 v3, v3, v4
    v_cmp_eq_u32 vcc, -1, v3
    s_nop 0
    s_cmp_lg_u64 vcc, 0
    s_cbranch_scc1 L_oc_35
    s_bitset0_b32 s55, 2
    v_mfma_f32_32x32x16_bf16 v[8:23], v[88:91], v[152:155], v[8:23]
    v_mfma_f32_32x32x16_bf16 v[24:39], v[88:91], v[156:159], v[24:39]
    v_mfma_f32_32x32x16_bf16 v[40:55], v[92:95], v[152:155], v[40:55]
    v_mfma_f32_32x32x16_bf16 v[56:71], v[92:95], v[156:159], v[56:71]
L_oc_35:
    s_bitcmp0_b32 s55, 3
    s_cbranch_scc1 L_oc_36
    v_max3_u32 v3, v160, v161, v162
    v_max3_u32 v4, v163, v164, v165
    v_max3_u32 v3, v3, v166, v167
    v_max_u32 v3, v3, v4
    v_cmp_eq_u32 vcc, -1, v3
    s_nop 0
    s_cmp_lg_u64 vcc, 0
    s_cbranch_scc1 L_oc_36
    s_bitset0_b32 s55, 3
    v_mfma_f32_32x32x16_bf16 v[8:23], v[96:99], v[160:163], v[8:23]
    v_mfma_f32_32x32x16_bf16 v[24:39], v[96:99], v[164:167], v[24:39]
    v_mfma_f32_32x32x16_bf16 v[40:55], v[100:103], v[160:163], v[40:55]
    v_mfma_f32_32x32x16_bf16 v[56:71], v[100:103], v[164:167], v[56:71]
L_oc_36:
    s_cmp_lt_u32 s55, 16
    s_cbranch_scc1 L_oh_37
    s_nop 3
    ds_read_b128 v[136:139], v2 offset:0
    ds_read_b128 v[140:143], v2 offset:1024
    ds_read_b128 v[144:147], v2 offset:2048
    ds_read_b128 v[148:151], v2 offset:3072
    ds_read_b128 v[152:155], v2 offset:4096
    ds_read_b128 v[156:159], v2 offset:5120
    ds_read_b128 v[160:163], v2 offset:6144
    ds_read_b128 v[164:167], v2 offset:7168
    s_bitcmp0_b32 s55, 4
    s_cbranch_scc1 L_oc_38
    s_waitcnt lgkmcnt(6)
    v_max3_u32 v3, v136, v137, v138
    v_max3_u32 v4, v139, v140, v141
    v_max3_u32 v3, v3, v142, v143
    v_max_u32 v3, v3, v4
    v_cmp_eq_u32 vcc, -1, v3
    s_nop 0
    s_cmp_lg_u64 vcc, 0
    s_cbranch_scc1 L_oc_38
    s_bitset0_b32 s55, 4
    v_mfma_f32_32x32x16_bf16 v[8:23], v[104:107], v[136:139], v[8:23]
    v_mfma_f32_32x32x16_bf16 v[24:39], v[104:107], v[140:143], v[24:39]
    v_mfma_f32_32x32x16_bf16 v[40:55], v[108:111], v[136:139], v[40:55]
    v_mfma_f32_32x32x16_bf16 v[56:71], v[108:111], v[140:143], v[56:71]
L_oc_38:
    s_bitcmp0_b32 s55, 5
    s_cbranch_scc1 L_oc_39
    s_waitcnt lgkmcnt(4)
    v_max3_u32 v3, v144, v145, v146
    v_max3_u32 v4, v147, v148, v149
    v_max3_u32 v3, v3, v150, v151
    v_max_u32 v3, v3, v4
    v_cmp_eq_u32 vcc, -1, v3
    s_nop 0
    s_cmp_lg_u64 vcc, 0
    s_cbranch_scc1 L_oc_39
    s_bitset0_b32 s55, 5
    v_mfma_f32_32x32x16_bf16 v[8:23], v[112:115], v[144:147], v[8:23]
    v_mfma_f32_32x32x16_bf16 v[24:39], v[112:115], v[148:151], v[24:39]
    v_mfma_f32_32x32x16_bf16 v[40:55], v[116:119], v[144:147], v[40:55]
    v_mfma_f32_32x32x16_bf16 v[56:71], v[116:119], v[148:151], v[56:71]
L_oc_39:
    s_bitcmp0_b32 s55, 6
    s_cbranch_scc1 L_oc_40
    s_waitcnt lgkmcnt(2)
    v_max3_u32 v3, v152, v153, v154
    v_max3_u32 v4, v155, v156, v157
    v_max3_u32 v3, v3, v158, v159
    v_max_u32 v3, v3, v4
    v_cmp_eq_u32 vcc, -1, v3
    s_nop 0
    s_cmp_lg_u64 vcc, 0
    s_cbranch_scc1 L_oc_40
    s_bitset0_b32 s55, 6
    v_mfma_f32_32x32x16_bf16 v[8:23], v[120:123], v[152:155], v[8:23]
    v_mfma_f32_32x32x16_bf16 v[24:39], v[120:123], v[156:159], v[24:39]
    v_mfma_f32_32x32x16_bf16 v[40:55], v[124:127], v[152:155], v[40:55]
    v_mfma_f32_32x32x16_bf16 v[56:71], v[124:127], v[156:159], v[56:71]
L_oc_40:
    s_bitcmp0_b32 s55, 7
    s_cbranch_scc1 L_oc_41
    s_waitcnt lgkmcnt(0)
    v_max3_u32 v3, v160, v161, v162
    v_max3_u32 v4, v163, v164, v165
    v_max3_u32 v3, v3, v166, v167
    v_max_u32 v3, v3, v4
    v_cmp_eq_u32 vcc, -1, v3
    s_nop 0
    s_cmp_lg_u64 vcc, 0
    s_cbranch_scc1 L_oc_41
    s_bitset0_b32 s55, 7
    v_mfma_f32_32x32x16_bf16 v[8:23], v[128:131], v[160:163], v[8:23]
    v_mfma_f32_32x32x16_bf16 v[24:39], v[128:131], v[164:167], v[24:39]
    v_mfma_f32_32x32x16_bf16 v[40:55], v[132:135], v[160:163], v[40:55]
    v_mfma_f32_32x32x16_bf16 v[56:71], v[132:135], v[164:167], v[56:71]
L_oc_41:
    s_waitcnt lgkmcnt(0)
L_oh_37:
    s_add_u32 s56, s56, 1
    s_cmp_eq_u32 s55, 0
    s_cbranch_scc1 L_odone
    s_cmp_lt_u32 s56, 262144
    s_cbranch_scc1 L_oround
L_odone:
    s_lshl_b32 s48, s50, 12
    s_add_u32 s48, s48, 65536
    v_add_u32 v3, s48, v1
    s_lshl_b32 s48, s50, 14
    s_add_u32 s48, s48, 65536
    v_add_u32 v4, s48, v1
    s_barrier
    s_nop 7
    ds_write_b128 v3, v[8:11] offset:0
    ds_write_b128 v3, v[12:15] offset:1024
    ds_write_b128 v3, v[16:19] offset:2048
    ds_write_b128 v3, v[20:23] offset:3072
    ds_write_b128 v3, v[24:27] offset:16384
    ds_write_b128 v3, v[28:31] offset:17408
    ds_write_b128 v3, v[32:35] offset:18432
    ds_write_b128 v3, v[36:39] offset:19456
    ds_write_b128 v3, v[40:43] offset:32768
    ds_write_b128 v3, v[44:47] offset:33792
    ds_write_b128 v3, v[48:51] offset:34816
    ds_write_b128 v3, v[52:55] offset:35840
    ds_write_b128 v3, v[56:59] offset:49152
    ds_write_b128 v3, v[60:63] offset:50176
    ds_write_b128 v3, v[64:67] offset:51200
    ds_write_b128 v3, v[68:71] offset:52224
    s_lshr_b32 s52, s50, 1
    s_and_b32 s53, s50, 1
    s_lshl1_add_u32 s48, s46, s53
    s_lshl_b32 s48, s48, 15
    s_lshl1_add_u32 s49, s47, s52
    s_lshl_b32 s49, s49, 6
    s_add_u32 s48, s48, s49
    v_and_b32 v7, 31, v0
    v_lshrrev_b32 v2, 5, v0
    v_lshlrev_b32 v7, 10, v7
    v_lshl_add_u32 v7, v2, 4, v7
    s_waitcnt lgkmcnt(0)
    s_barrier
    ds_read_b128 v[8:11], v4 offset:0
    ds_read_b128 v[12:15], v4 offset:1024
    ds_read_b128 v[16:19], v4 offset:2048
    ds_read_b128 v[20:23], v4 offset:3072
    ds_read_b128 v[24:27], v4 offset:4096
    ds_read_b128 v[28:31], v4 offset:5120
    ds_read_b128 v[32:35], v4 offset:6144
    ds_read_b128 v[36:39], v4 offset:7168
    ds_read_b128 v[40:43], v4 offset:8192
    ds_read_b128 v[44:47], v4 offset:9216
    ds_read_b128 v[48:51], v4 offset:10240
    ds_read_b128 v[52:55], v4 offset:11264
    ds_read_b128 v[56:59], v4 offset:12288
    ds_read_b128 v[60:63], v4 offset:13312
    ds_read_b128 v[64:67], v4 offset:14336
    ds_read_b128 v[68:71], v4 offset:15360
    s_waitcnt lgkmcnt(8)
    v_add_f32 v8, v8, v24
    v_add_f32 v9, v9, v25
    v_add_f32 v10, v10, v26
    v_add_f32 v11, v11, v27
    v_add_f32 v12, v12, v28
    v_add_f32 v13, v13, v29
    v_add_f32 v14, v14, v30
    v_add_f32 v15, v15, v31
    v_add_f32 v16, v16, v32
    v_add_f32 v17, v17, v33
    v_add_f32 v18, v18, v34
    v_add_f32 v19, v19, v35
    v_add_f32 v20, v20, v36
    v_add_f32 v21, v21, v37
    v_add_f32 v22, v22, v38
    v_add_f32 v23, v23, v39
    s_waitcnt lgkmcnt(0)
    v_add_f32 v40, v40, v56
    v_add_f32 v41, v41, v57
    v_add_f32 v42, v42, v58
    v_add_f32 v43, v43, v59
    v_add_f32 v44, v44, v60
    v_add_f32 v45, v45, v61
    v_add_f32 v46, v46, v62
    v_add_f32 v47, v47, v63
    v_add_f32 v48, v48, v64
    v_add_f32 v49, v49, v65
    v_add_f32 v50, v50, v66
    v_add_f32 v51, v51, v67
    v_add_f32 v52, v52, v68
    v_add_f32 v53, v53, v69
    v_add_f32 v54, v54, v70
    v_add_f32 v55, v55, v71
    v_add_f32 v8, v8, v40
    v_add_f32 v9, v9, v41
    v_add_f32 v10, v10, v42
    v_add_f32 v11, v11, v43
    v_add_f32 v12, v12, v44
    v_add_f32 v13, v13, v45
    v_add_f32 v14, v14, v46
    v_add_f32 v15, v15, v47
    v_add_f32 v16, v16, v48
    v_add_f32 v17, v17, v49
    v_add_f32 v18, v18, v50
    v_add_f32 v19, v19, v51
    v_add_f32 v20, v20, v52
    v_add_f32 v21, v21, v53
    v_add_f32 v22, v22, v54
    v_add_f32 v23, v23, v55
    v_cvt_pk_bf16_f32 v8, v8, v9
    v_cvt_pk_bf16_f32 v9, v10, v11
    v_cvt_pk_bf16_f32 v10, v12, v13
    v_cvt_pk_bf16_f32 v11, v14, v15
    v_cvt_pk_bf16_f32 v12, v16, v17
    v_cvt_pk_bf16_f32 v13, v18, v19
    v_cvt_pk_bf16_f32 v14, v20, v21
    v_cvt_pk_bf16_f32 v15, v22, v23
    s_nop 1
    v_permlane32_swap_b32 v8, v10
    v_permlane32_swap_b32 v9, v11
    v_permlane32_swap_b32 v12, v14
    v_permlane32_swap_b32 v13, v15
    s_nop 1
    buffer_store_dwordx4 v[8:11], v7, s[20:23], s48 offen
    buffer_store_dwordx4 v[12:15], v7, s[20:23], s48 offen offset:32
L_end:
    s_endpgm
.section .rodata,"a"
.p2align 6
.amdhsa_kernel gated_mix__softmax_full_mha__dense_activation_mish__prompt_kernel
  .amdhsa_next_free_vgpr 168
  .amdhsa_next_free_sgpr 102
  .amdhsa_accum_offset 168
  .amdhsa_group_segment_fixed_size 0
  .amdhsa_kernarg_size 88
  .amdhsa_user_sgpr_count 2
  .amdhsa_user_sgpr_kernarg_segment_ptr 1
  .amdhsa_system_sgpr_workgroup_id_x 1
.end_amdhsa_kernel
```
